```python
import torch

def _softmax(x, axis=-1):
    return torch.softmax(x, dim=axis)
def _gelu(x):
    return torch.nn.functional.gelu(x, approximate="tanh")
def _silu(x):
    return torch.nn.functional.silu(x)
def _sigmoid(x):
    return torch.sigmoid(x)
def _layernorm(x, axis=-1, eps=1e-5):
    m = x.mean(dim=axis, keepdim=True)
    v = x.var(dim=axis, keepdim=True, unbiased=False)
    return (x - m) / torch.sqrt(v + eps)
def _scatter_add(tgt, idx, src, axis=0):
    return tgt.clone().index_add_(axis, idx, src)
def _segment_sum(src, seg, n):
    out = torch.zeros((n,) + src.shape[1:], dtype=src.dtype)
    return out.index_add_(0, seg, src)
def _pad(x, pw):
    flat = tuple(v for pair in reversed(pw) for v in pair)
    return torch.nn.functional.pad(x, flat)

kernel_name = 'gated_mix__mha_block_cached__glu_gated_bilinear__decode'

def setup_inputs():

    _w = (lambda a: (lambda t: t.to(torch.bfloat16) if t.is_floating_point() else t)(torch.as_tensor(a)))
    def _A_setup():
        B, Sq, D = 4, 1, 640
        H, Sk, Dh = 32, 4096, 128
        return {
            "x": _w((lambda *s: torch.randn(*s, dtype=torch.bfloat16) * 0.05)(B, Sq, D)),
            "k_cache": _w((lambda *s: torch.randn(*s, dtype=torch.bfloat16) * 6.4)(B, H, Sk, Dh)),
            "v_cache": _w((lambda *s: torch.randn(*s, dtype=torch.bfloat16) * 0.05)(B, H, Sk, Dh)),
            "wq": _w((lambda *s: torch.randn(*s, dtype=torch.bfloat16) * 6.4)(D, H * Dh) * (D ** -0.5)),
            "wo": _w((lambda *s: torch.randn(*s, dtype=torch.bfloat16) * 0.05)(H * Dh, D) * ((H * Dh) ** -0.5)),
        }
    _A_in = _A_setup()

    def _B_setup():
        B, S, D, F = 4, 1, 640, 1728
        return {
            "x": _w((lambda *s: torch.randn(*s, dtype=torch.bfloat16) * 0.05)(B, S, D)),
            "w_gate": _w((lambda *s: torch.randn(*s, dtype=torch.bfloat16) * 0.4)(D, F) * (D ** -0.5)),
            "w_up": _w((lambda *s: torch.randn(*s, dtype=torch.bfloat16) * 0.4)(D, F) * (D ** -0.5)),
            "w_down": _w((lambda *s: torch.randn(*s, dtype=torch.bfloat16) * 0.4)(F, D) * (F ** -0.5)),
        }
    _B_in = _B_setup()

    return {
        "A_x": _A_in["x"],
        "A_k_cache": _A_in["k_cache"],
        "A_v_cache": _A_in["v_cache"],
        "A_wq": _A_in["wq"],
        "A_wo": _A_in["wo"],
        "B_x": _B_in["x"],
        "B_w_gate": _B_in["w_gate"],
        "B_w_up": _B_in["w_up"],
        "B_w_down": _B_in["w_down"],
        "gate_w": _w((lambda *s: torch.randn(*s, dtype=torch.bfloat16) * 0.05)(640) * 16.0),
    }

def reference(A_x, A_k_cache, A_v_cache, A_wq, A_wo, B_x, B_w_gate, B_w_up, B_w_down, gate_w):
    def _A_ref(x, k_cache, v_cache, wq, wo):
        B, Sq, D = x.shape
        H, Dh = 32, 128
        q = (lambda x, *d: x.permute(*d))((x @ wq).reshape(B, Sq, H, Dh), 0, 2, 1, 3)
        scores = torch.einsum("bhqd,bhkd->bhqk", q, k_cache) * (Dh ** -0.5)
        p = _softmax(scores, axis=-1)
        o = torch.einsum("bhqk,bhkd->bhqd", p, v_cache)
        return (lambda x, *d: x.permute(*d))(o, 0, 2, 1, 3).reshape(B, Sq, H * Dh) @ wo

    def _B_ref(x, w_gate, w_up, w_down):
        g = torch.einsum("bsd,df->bsf", x, w_gate)
        u = torch.einsum("bsd,df->bsf", x, w_up)
        h = g * u
        return torch.einsum("bsf,fd->bsd", h, w_down)

    x = A_x
    g = _sigmoid((x * gate_w).sum(-1, keepdims=True))
    a = _A_ref(x, A_k_cache, A_v_cache, A_wq, A_wo)
    b = _B_ref(x, B_w_gate, B_w_up, B_w_down)
    return g * a + (1 - g) * b
```

```asm
; @launch grid=(256,1,1) block=(320,1,1) lds=20480
.amdgcn_target "amdgcn-amd-amdhsa--gfx950"
.text
.globl gated_mix__mha_block_cached__glu_gated_bilinear__decode_kernel
.p2align 8
.type gated_mix__mha_block_cached__glu_gated_bilinear__decode_kernel,@function
gated_mix__mha_block_cached__glu_gated_bilinear__decode_kernel:
  s_cmp_ge_u32 s2, 256
  s_cbranch_scc1 L_end
  s_memrealtime s[100:101]
  s_load_dwordx16 s[16:31], s[0:1], 0
  s_load_dwordx8 s[32:39], s[0:1], 64
  s_load_dwordx2 s[40:41], s[0:1], 96
  v_and_b32 v40, 63, v0
  v_lshrrev_b32 v41, 6, v0
  s_nop 0
  v_readfirstlane_b32 s3, v41
  v_lshrrev_b32 v42, 4, v40
  v_and_b32 v43, 15, v40
  v_lshlrev_b32 v1, 4, v40
  s_and_b32 s74, s2, 7
  s_lshr_b32 s75, s2, 3
  s_and_b32 s76, s75, 3
  s_lshl_b32 s74, s74, 2
  s_add_u32 s94, s74, s76
  s_lshr_b32 s75, s75, 2
  s_lshr_b32 s81, s75, 1
  s_and_b32 s95, s75, 1
  s_lshl_b32 s73, s81, 5
  s_add_u32 s73, s73, s94
  s_lshl_b32 s73, s73, 1
  s_add_u32 s73, s73, s95
  s_mov_b32 s78, 0x3fb8aa3b
  s_mov_b32 s80, 0xffff0000
  s_cmp_eq_u32 s3, 4
  s_cbranch_scc1 L_comm
  v_and_b32 v38, 7, v40
  v_lshrrev_b32 v29, 3, v43
  v_lshl_add_u32 v41, v29, 2, v42
  v_lshlrev_b32 v2, 13, v41
  v_lshl_add_u32 v2, v38, 4, v2
  v_mul_u32_u24 v28, 3456, v41
  v_lshl_add_u32 v28, v38, 4, v28
  v_lshl_add_u32 v44, v38, 3, v41
  v_lshlrev_b32 v44, 1, v44
  s_sub_u32 s77, s2, 128
  s_and_b32 s77, s77, 127
  s_mul_i32 s74, s77, 1214
  s_lshr_b32 s74, s74, 15
  s_mul_i32 s75, s74, 27
  s_sub_u32 s75, s77, s75
  s_lshl_b32 s75, s75, 7
  s_lshr_b32 s76, s74, 1
  s_and_b32 s93, s74, 1
  s_lshl_b32 s72, s94, 1
  s_add_u32 s72, s72, s95
  s_lshl_b32 s72, s72, 7
  s_movk_i32 s99, 3456
  s_cmp_lt_u32 s2, 128
  s_cselect_b32 s75, s72, s75
  s_cselect_b32 s76, s81, s76
  s_cselect_b32 s99, 8192, s99
  s_mul_i32 s72, s76, 320
  s_mul_i32 s98, s3, 80
  s_add_u32 s72, s72, s98
  s_cmp_lt_u32 s2, 236
  s_cselect_b32 s72, s72, 0
  s_cselect_b32 s77, 0, 0x40000000
  s_mul_i32 s70, s72, s99
  s_add_u32 s70, s70, s75
  s_lshl_b32 s92, s99, 3
  s_lshl_b32 s72, s72, 1
  v_mul_u32_u24 v2, s99, v41
  v_lshl_add_u32 v2, v38, 4, v2
  v_or_b32 v2, s77, v2
  s_lshl_b32 s68, s73, 19
  s_lshl_b32 s77, s3, 12
  s_add_u32 s68, s68, s77
  s_mov_b32 s69, s68
  s_waitcnt lgkmcnt(0)
  s_mov_b32 s60, s16
  s_mov_b32 s61, s17
  s_mov_b32 s62, 5120
  s_mov_b32 s63, 0x00020000
  s_cmp_eq_u32 s93, 0
  s_cselect_b32 s52, s28, s30
  s_cselect_b32 s53, s29, s31
  s_cmp_lt_u32 s2, 128
  s_cselect_b32 s52, s22, s52
  s_cselect_b32 s53, s23, s53
  s_mov_b32 s54, 2211840
  s_cselect_b32 s54, 5242880, s54
  s_mov_b32 s55, 0x00020000
  buffer_load_ushort v72, v44, s[60:63], s72 offen offset:0
  buffer_load_ushort v73, v44, s[60:63], s72 offen offset:1280
  buffer_load_ushort v74, v44, s[60:63], s72 offen offset:2560
  buffer_load_ushort v75, v44, s[60:63], s72 offen offset:3840
  s_mov_b32 s44, s18
  s_mov_b32 s45, s19
  s_mov_b32 s46, 134217728
  s_mov_b32 s47, 0x00020000
  buffer_load_dwordx4 v[80:83], v2, s[52:55], s70 offen nt
  s_add_u32 s70, s70, s92
  buffer_load_dwordx4 v[84:87], v2, s[52:55], s70 offen nt
  s_add_u32 s70, s70, s92
  buffer_load_dwordx4 v[88:91], v2, s[52:55], s70 offen nt
  s_add_u32 s70, s70, s92
  buffer_load_dwordx4 v[92:95], v2, s[52:55], s70 offen nt
  s_add_u32 s70, s70, s92
  buffer_load_dwordx4 v[96:99], v2, s[52:55], s70 offen nt
  s_add_u32 s70, s70, s92
  buffer_load_ushort v76, v44, s[60:63], s72 offen offset:80
  buffer_load_ushort v77, v44, s[60:63], s72 offen offset:1360
  buffer_load_ushort v78, v44, s[60:63], s72 offen offset:2640
  buffer_load_ushort v79, v44, s[60:63], s72 offen offset:3920
  buffer_load_dwordx4 v[100:103], v2, s[52:55], s70 offen nt
  s_add_u32 s70, s70, s92
  buffer_load_dwordx4 v[104:107], v2, s[52:55], s70 offen nt
  s_add_u32 s70, s70, s92
  buffer_load_dwordx4 v[108:111], v2, s[52:55], s70 offen nt
  s_add_u32 s70, s70, s92
  buffer_load_dwordx4 v[112:115], v2, s[52:55], s70 offen nt
  s_add_u32 s70, s70, s92
  buffer_load_dwordx4 v[116:119], v2, s[52:55], s70 offen nt
  buffer_load_dwordx4 v[120:123], v1, s[44:47], s68 offen offset:0 nt
  buffer_load_dwordx4 v[124:127], v1, s[44:47], s68 offen offset:1024 nt
  s_mov_b32 s48, s20
  s_mov_b32 s49, s21
  s_mov_b32 s50, 134217728
  s_mov_b32 s51, 0x00020000
  s_mov_b32 s56, s24
  s_mov_b32 s57, s25
  s_mov_b32 s58, 5242880
  s_mov_b32 s59, 0x00020000
  s_mov_b32 s64, s40
  s_mov_b32 s65, s41
  s_mov_b32 s66, 2885632
  s_mov_b32 s67, 0x00020000
  s_mov_b32 s8, s32
  s_mov_b32 s9, s33
  s_mov_b32 s10, 2211840
  s_mov_b32 s11, 0x00020000
  s_mul_i32 s71, s94, 163840
  s_lshl_b32 s77, s3, 8
  s_add_u32 s71, s71, s77
  v_mul_u32_u24 v3, 1280, v42
  v_lshl_add_u32 v3, v43, 4, v3
  v_lshrrev_b32 v45, 1, v38
  v_and_b32 v46, 1, v40
  v_lshlrev_b32 v46, 4, v46
  v_mov_b32 v41, 0xffff
  v_lshlrev_b32 v46, v46, v41
  v_cmp_eq_u32 vcc, 0, v45
  s_nop 1
  v_cndmask_b32 v4, 0, v46, vcc
  v_cmp_eq_u32 vcc, 1, v45
  s_nop 1
  v_cndmask_b32 v5, 0, v46, vcc
  v_cmp_eq_u32 vcc, 2, v45
  s_nop 1
  v_cndmask_b32 v6, 0, v46, vcc
  v_cmp_eq_u32 vcc, 3, v45
  s_nop 1
  v_cndmask_b32 v7, 0, v46, vcc
  v_lshl_add_u32 v47, v42, 5, v38
  v_lshlrev_b32 v47, 2, v47
  s_mov_b32 s79, 0x3db504f3
  s_sub_u32 s76, s2, 121
  s_cmp_lt_u32 s76, 135
  s_cselect_b32 s75, s76, 0
  s_cselect_b32 s76, 0, 0x40000000
  s_mul_i32 s74, s75, 205
  s_lshr_b32 s74, s74, 10
  s_mul_i32 s77, s74, 5
  s_sub_u32 s75, s75, s77
  s_lshl_b32 s74, s74, 6
  s_lshl_b32 s77, s3, 4
  s_add_u32 s74, s74, s77
  s_mul_i32 s93, s74, 1280
  s_lshl_b32 s75, s75, 8
  s_add_u32 s93, s93, s75
  v_or_b32 v39, s76, v3
  s_mul_i32 s96, s73, 2560
  s_lshl_b32 s76, s3, 9
  s_add_u32 s96, s96, s76
  s_add_u32 s96, s96, 65536
  v_lshrrev_b32 v41, 1, v42
  v_and_b32 v44, 1, v42
  v_lshl_add_u32 v44, v44, 5, v38
  v_lshlrev_b32 v44, 2, v44
  v_lshl_add_u32 v44, v41, 10, v44
  s_lshl_b32 s77, s3, 11
  v_add_u32 v37, s77, v44
  v_cmp_eq_u32 s[98:99], v41, v29
  s_mov_b64 exec, 0
  s_cmp_eq_u32 s3, 1
  s_cbranch_scc1 L_wseg3_1
  s_cmp_eq_u32 s3, 2
  s_cbranch_scc1 L_wseg3_2
  s_cmp_eq_u32 s3, 3
  s_cbranch_scc1 L_wseg3_3
  s_branch L_wseg3_0
L_wret3:
  s_mov_b64 exec, -1
  s_barrier
L_wseg3_0:
L_hop205:
  s_cbranch_execz L_hop218
  s_waitcnt vmcnt(16)
  v_lshl_or_b32 v72, v72, 16, v72
  v_lshl_or_b32 v73, v73, 16, v73
  v_lshl_or_b32 v74, v74, 16, v74
  v_lshl_or_b32 v75, v75, 16, v75
  s_waitcnt vmcnt(15)
  v_mov_b32_dpp v45, v72 row_newbcast:0 row_mask:0xf bank_mask:0x3
  v_mov_b32_dpp v45, v72 row_newbcast:8 row_mask:0xf bank_mask:0xc
  v_and_b32 v12, v45, v4
  v_and_b32 v13, v45, v5
  v_and_b32 v14, v45, v6
  v_and_b32 v15, v45, v7
L_hop218:
  s_cbranch_execz L_hop241
  s_nop 1
  v_mfma_f32_16x16x32_bf16 v[48:51], v[80:83], v[12:15], 0
  v_mov_b32_dpp v41, v73 row_newbcast:0 row_mask:0xf bank_mask:0x3
  v_mov_b32_dpp v41, v73 row_newbcast:8 row_mask:0xf bank_mask:0xc
  v_and_b32 v16, v41, v4
  v_and_b32 v17, v41, v5
  v_and_b32 v18, v41, v6
  v_and_b32 v19, v41, v7
  s_nop 1
  v_mfma_f32_16x16x32_bf16 v[52:55], v[80:83], v[16:19], 0
  v_mov_b32_dpp v45, v74 row_newbcast:0 row_mask:0xf bank_mask:0x3
  v_mov_b32_dpp v45, v74 row_newbcast:8 row_mask:0xf bank_mask:0xc
  v_and_b32 v12, v45, v4
  v_and_b32 v13, v45, v5
  v_and_b32 v14, v45, v6
  v_and_b32 v15, v45, v7
  s_nop 1
  v_mfma_f32_16x16x32_bf16 v[56:59], v[80:83], v[12:15], 0
  v_mov_b32_dpp v41, v75 row_newbcast:0 row_mask:0xf bank_mask:0x3
  v_mov_b32_dpp v41, v75 row_newbcast:8 row_mask:0xf bank_mask:0xc
  v_and_b32 v16, v41, v4
  v_and_b32 v17, v41, v5
L_hop241:
  s_cbranch_execz L_hop265
  v_and_b32 v18, v41, v6
  v_and_b32 v19, v41, v7
  s_nop 1
  v_mfma_f32_16x16x32_bf16 v[60:63], v[80:83], v[16:19], 0
  buffer_load_dwordx4 v[128:131], v1, s[44:47], s68 offen offset:2048 nt
  s_waitcnt vmcnt(15)
  v_mov_b32_dpp v45, v72 row_newbcast:1 row_mask:0xf bank_mask:0x3
  v_mov_b32_dpp v45, v72 row_newbcast:9 row_mask:0xf bank_mask:0xc
  v_and_b32 v12, v45, v4
  v_and_b32 v13, v45, v5
  v_and_b32 v14, v45, v6
  v_and_b32 v15, v45, v7
  s_nop 1
  v_mfma_f32_16x16x32_bf16 v[48:51], v[84:87], v[12:15], v[48:51]
  v_mov_b32_dpp v41, v73 row_newbcast:1 row_mask:0xf bank_mask:0x3
  v_mov_b32_dpp v41, v73 row_newbcast:9 row_mask:0xf bank_mask:0xc
  v_and_b32 v16, v41, v4
  v_and_b32 v17, v41, v5
  v_and_b32 v18, v41, v6
  v_and_b32 v19, v41, v7
  s_nop 1
  v_mfma_f32_16x16x32_bf16 v[52:55], v[84:87], v[16:19], v[52:55]
  v_mov_b32_dpp v45, v74 row_newbcast:1 row_mask:0xf bank_mask:0x3
L_hop265:
  s_cbranch_execz L_hop287
  v_mov_b32_dpp v45, v74 row_newbcast:9 row_mask:0xf bank_mask:0xc
  v_and_b32 v12, v45, v4
  v_and_b32 v13, v45, v5
  v_and_b32 v14, v45, v6
  v_and_b32 v15, v45, v7
  s_nop 1
  v_mfma_f32_16x16x32_bf16 v[56:59], v[84:87], v[12:15], v[56:59]
  v_mov_b32_dpp v41, v75 row_newbcast:1 row_mask:0xf bank_mask:0x3
  v_mov_b32_dpp v41, v75 row_newbcast:9 row_mask:0xf bank_mask:0xc
  v_and_b32 v16, v41, v4
  v_and_b32 v17, v41, v5
  v_and_b32 v18, v41, v6
  v_and_b32 v19, v41, v7
  s_nop 1
  v_mfma_f32_16x16x32_bf16 v[60:63], v[84:87], v[16:19], v[60:63]
  buffer_load_dwordx4 v[132:135], v1, s[44:47], s68 offen offset:3072 nt
  s_add_u32 s68, s68, 16384
  s_waitcnt vmcnt(15)
  v_mov_b32_dpp v45, v72 row_newbcast:2 row_mask:0xf bank_mask:0x3
  v_mov_b32_dpp v45, v72 row_newbcast:10 row_mask:0xf bank_mask:0xc
  v_and_b32 v12, v45, v4
L_hop287:
  s_cbranch_execz L_hop311
  v_and_b32 v13, v45, v5
  v_and_b32 v14, v45, v6
  v_and_b32 v15, v45, v7
  s_nop 1
  v_mfma_f32_16x16x32_bf16 v[48:51], v[88:91], v[12:15], v[48:51]
  v_mov_b32_dpp v41, v73 row_newbcast:2 row_mask:0xf bank_mask:0x3
  v_mov_b32_dpp v41, v73 row_newbcast:10 row_mask:0xf bank_mask:0xc
  v_and_b32 v16, v41, v4
  v_and_b32 v17, v41, v5
  v_and_b32 v18, v41, v6
  v_and_b32 v19, v41, v7
  s_nop 1
  v_mfma_f32_16x16x32_bf16 v[52:55], v[88:91], v[16:19], v[52:55]
  v_mov_b32_dpp v45, v74 row_newbcast:2 row_mask:0xf bank_mask:0x3
  v_mov_b32_dpp v45, v74 row_newbcast:10 row_mask:0xf bank_mask:0xc
  v_and_b32 v12, v45, v4
  v_and_b32 v13, v45, v5
  v_and_b32 v14, v45, v6
  v_and_b32 v15, v45, v7
  s_nop 1
  v_mfma_f32_16x16x32_bf16 v[56:59], v[88:91], v[12:15], v[56:59]
  v_mov_b32_dpp v41, v75 row_newbcast:2 row_mask:0xf bank_mask:0x3
  v_mov_b32_dpp v41, v75 row_newbcast:10 row_mask:0xf bank_mask:0xc
L_hop311:
  s_cbranch_execz L_wret3
  v_and_b32 v16, v41, v4
  v_and_b32 v17, v41, v5
  v_and_b32 v18, v41, v6
  v_and_b32 v19, v41, v7
  s_nop 1
  v_mfma_f32_16x16x32_bf16 v[60:63], v[88:91], v[16:19], v[60:63]
  buffer_load_dwordx4 v[136:139], v1, s[44:47], s68 offen offset:0 nt
  s_waitcnt vmcnt(15)
  v_mov_b32_dpp v45, v72 row_newbcast:3 row_mask:0xf bank_mask:0x3
  v_mov_b32_dpp v45, v72 row_newbcast:11 row_mask:0xf bank_mask:0xc
  v_and_b32 v12, v45, v4
  v_and_b32 v13, v45, v5
  v_and_b32 v14, v45, v6
  v_and_b32 v15, v45, v7
  s_nop 1
  v_mfma_f32_16x16x32_bf16 v[48:51], v[92:95], v[12:15], v[48:51]
  v_mov_b32_dpp v41, v73 row_newbcast:3 row_mask:0xf bank_mask:0x3
  v_mov_b32_dpp v41, v73 row_newbcast:11 row_mask:0xf bank_mask:0xc
  v_and_b32 v16, v41, v4
  v_and_b32 v17, v41, v5
  v_and_b32 v18, v41, v6
  v_and_b32 v19, v41, v7
  s_nop 1
L_wseg3_1:
L_hop335:
  s_cbranch_execz L_hop357
  v_mfma_f32_16x16x32_bf16 v[52:55], v[92:95], v[16:19], v[52:55]
  v_mov_b32_dpp v45, v74 row_newbcast:3 row_mask:0xf bank_mask:0x3
  v_mov_b32_dpp v45, v74 row_newbcast:11 row_mask:0xf bank_mask:0xc
  v_and_b32 v12, v45, v4
  v_and_b32 v13, v45, v5
  v_and_b32 v14, v45, v6
  v_and_b32 v15, v45, v7
  s_nop 1
  v_mfma_f32_16x16x32_bf16 v[56:59], v[92:95], v[12:15], v[56:59]
  v_mov_b32_dpp v41, v75 row_newbcast:3 row_mask:0xf bank_mask:0x3
  v_mov_b32_dpp v41, v75 row_newbcast:11 row_mask:0xf bank_mask:0xc
  v_and_b32 v16, v41, v4
  v_and_b32 v17, v41, v5
  v_and_b32 v18, v41, v6
  v_and_b32 v19, v41, v7
  s_nop 1
  v_mfma_f32_16x16x32_bf16 v[60:63], v[92:95], v[16:19], v[60:63]
  buffer_load_dwordx4 v[140:143], v1, s[44:47], s68 offen offset:1024 nt
  s_waitcnt vmcnt(15)
  v_mov_b32_dpp v45, v72 row_newbcast:4 row_mask:0xf bank_mask:0x3
  v_mov_b32_dpp v45, v72 row_newbcast:12 row_mask:0xf bank_mask:0xc
L_hop357:
  s_cbranch_execz L_hop381
  v_and_b32 v12, v45, v4
  v_and_b32 v13, v45, v5
  v_and_b32 v14, v45, v6
  v_and_b32 v15, v45, v7
  s_nop 1
  v_mfma_f32_16x16x32_bf16 v[48:51], v[96:99], v[12:15], v[48:51]
  v_mov_b32_dpp v41, v73 row_newbcast:4 row_mask:0xf bank_mask:0x3
  v_mov_b32_dpp v41, v73 row_newbcast:12 row_mask:0xf bank_mask:0xc
  v_and_b32 v16, v41, v4
  v_and_b32 v17, v41, v5
  v_and_b32 v18, v41, v6
  v_and_b32 v19, v41, v7
  s_nop 1
  v_mfma_f32_16x16x32_bf16 v[52:55], v[96:99], v[16:19], v[52:55]
  v_mov_b32_dpp v45, v74 row_newbcast:4 row_mask:0xf bank_mask:0x3
  v_mov_b32_dpp v45, v74 row_newbcast:12 row_mask:0xf bank_mask:0xc
  v_and_b32 v12, v45, v4
  v_and_b32 v13, v45, v5
  v_and_b32 v14, v45, v6
  v_and_b32 v15, v45, v7
  s_nop 1
  v_mfma_f32_16x16x32_bf16 v[56:59], v[96:99], v[12:15], v[56:59]
  v_mov_b32_dpp v41, v75 row_newbcast:4 row_mask:0xf bank_mask:0x3
L_hop381:
  s_cbranch_execz L_hop404
  v_mov_b32_dpp v41, v75 row_newbcast:12 row_mask:0xf bank_mask:0xc
  v_and_b32 v16, v41, v4
  v_and_b32 v17, v41, v5
  v_and_b32 v18, v41, v6
  v_and_b32 v19, v41, v7
  s_nop 1
  v_mfma_f32_16x16x32_bf16 v[60:63], v[96:99], v[16:19], v[60:63]
  buffer_load_dwordx4 v[144:147], v1, s[44:47], s68 offen offset:2048 nt
  s_waitcnt vmcnt(12)
  v_lshl_or_b32 v76, v76, 16, v76
  v_lshl_or_b32 v77, v77, 16, v77
  v_lshl_or_b32 v78, v78, 16, v78
  v_lshl_or_b32 v79, v79, 16, v79
  s_waitcnt vmcnt(11)
  v_mov_b32_dpp v45, v76 row_newbcast:0 row_mask:0xf bank_mask:0x3
  v_mov_b32_dpp v45, v76 row_newbcast:8 row_mask:0xf bank_mask:0xc
  v_and_b32 v12, v45, v4
  v_and_b32 v13, v45, v5
  v_and_b32 v14, v45, v6
  v_and_b32 v15, v45, v7
  s_nop 1
  v_mfma_f32_16x16x32_bf16 v[48:51], v[100:103], v[12:15], v[48:51]
L_hop404:
  s_cbranch_execz L_hop427
  v_mov_b32_dpp v41, v77 row_newbcast:0 row_mask:0xf bank_mask:0x3
  v_mov_b32_dpp v41, v77 row_newbcast:8 row_mask:0xf bank_mask:0xc
  v_and_b32 v16, v41, v4
  v_and_b32 v17, v41, v5
  v_and_b32 v18, v41, v6
  v_and_b32 v19, v41, v7
  s_nop 1
  v_mfma_f32_16x16x32_bf16 v[52:55], v[100:103], v[16:19], v[52:55]
  v_mov_b32_dpp v45, v78 row_newbcast:0 row_mask:0xf bank_mask:0x3
  v_mov_b32_dpp v45, v78 row_newbcast:8 row_mask:0xf bank_mask:0xc
  v_and_b32 v12, v45, v4
  v_and_b32 v13, v45, v5
  v_and_b32 v14, v45, v6
  v_and_b32 v15, v45, v7
  s_nop 1
  v_mfma_f32_16x16x32_bf16 v[56:59], v[100:103], v[12:15], v[56:59]
  v_mov_b32_dpp v41, v79 row_newbcast:0 row_mask:0xf bank_mask:0x3
  v_mov_b32_dpp v41, v79 row_newbcast:8 row_mask:0xf bank_mask:0xc
  v_and_b32 v16, v41, v4
  v_and_b32 v17, v41, v5
  v_and_b32 v18, v41, v6
  v_and_b32 v19, v41, v7
L_hop427:
  s_cbranch_execz L_hop450
  s_nop 1
  v_mfma_f32_16x16x32_bf16 v[60:63], v[100:103], v[16:19], v[60:63]
  buffer_load_dwordx4 v[148:151], v1, s[44:47], s68 offen offset:3072 nt
  s_add_u32 s68, s68, 16384
  s_waitcnt vmcnt(11)
  v_mov_b32_dpp v45, v76 row_newbcast:1 row_mask:0xf bank_mask:0x3
  v_mov_b32_dpp v45, v76 row_newbcast:9 row_mask:0xf bank_mask:0xc
  v_and_b32 v12, v45, v4
  v_and_b32 v13, v45, v5
  v_and_b32 v14, v45, v6
  v_and_b32 v15, v45, v7
  s_nop 1
  v_mfma_f32_16x16x32_bf16 v[48:51], v[104:107], v[12:15], v[48:51]
  v_mov_b32_dpp v41, v77 row_newbcast:1 row_mask:0xf bank_mask:0x3
  v_mov_b32_dpp v41, v77 row_newbcast:9 row_mask:0xf bank_mask:0xc
  v_and_b32 v16, v41, v4
  v_and_b32 v17, v41, v5
  v_and_b32 v18, v41, v6
  v_and_b32 v19, v41, v7
  s_nop 1
  v_mfma_f32_16x16x32_bf16 v[52:55], v[104:107], v[16:19], v[52:55]
  v_mov_b32_dpp v45, v78 row_newbcast:1 row_mask:0xf bank_mask:0x3
L_hop450:
  s_cbranch_execz L_wret3
  v_mov_b32_dpp v45, v78 row_newbcast:9 row_mask:0xf bank_mask:0xc
  v_and_b32 v12, v45, v4
  v_and_b32 v13, v45, v5
  v_and_b32 v14, v45, v6
  v_and_b32 v15, v45, v7
  s_nop 1
  v_mfma_f32_16x16x32_bf16 v[56:59], v[104:107], v[12:15], v[56:59]
  v_mov_b32_dpp v41, v79 row_newbcast:1 row_mask:0xf bank_mask:0x3
  v_mov_b32_dpp v41, v79 row_newbcast:9 row_mask:0xf bank_mask:0xc
  v_and_b32 v16, v41, v4
  v_and_b32 v17, v41, v5
  v_and_b32 v18, v41, v6
  v_and_b32 v19, v41, v7
  s_nop 1
  v_mfma_f32_16x16x32_bf16 v[60:63], v[104:107], v[16:19], v[60:63]
  buffer_load_dwordx4 v[152:155], v1, s[44:47], s68 offen offset:0 nt
  s_waitcnt vmcnt(11)
  v_mov_b32_dpp v45, v76 row_newbcast:2 row_mask:0xf bank_mask:0x3
  v_mov_b32_dpp v45, v76 row_newbcast:10 row_mask:0xf bank_mask:0xc
  v_and_b32 v12, v45, v4
  v_and_b32 v13, v45, v5
  v_and_b32 v14, v45, v6
L_wseg3_2:
L_hop473:
  s_cbranch_execz L_hop496
  v_and_b32 v15, v45, v7
  s_nop 1
  v_mfma_f32_16x16x32_bf16 v[48:51], v[108:111], v[12:15], v[48:51]
  v_mov_b32_dpp v41, v77 row_newbcast:2 row_mask:0xf bank_mask:0x3
  v_mov_b32_dpp v41, v77 row_newbcast:10 row_mask:0xf bank_mask:0xc
  v_and_b32 v16, v41, v4
  v_and_b32 v17, v41, v5
  v_and_b32 v18, v41, v6
  v_and_b32 v19, v41, v7
  s_nop 1
  v_mfma_f32_16x16x32_bf16 v[52:55], v[108:111], v[16:19], v[52:55]
  v_mov_b32_dpp v45, v78 row_newbcast:2 row_mask:0xf bank_mask:0x3
  v_mov_b32_dpp v45, v78 row_newbcast:10 row_mask:0xf bank_mask:0xc
  v_and_b32 v12, v45, v4
  v_and_b32 v13, v45, v5
  v_and_b32 v14, v45, v6
  v_and_b32 v15, v45, v7
  s_nop 1
  v_mfma_f32_16x16x32_bf16 v[56:59], v[108:111], v[12:15], v[56:59]
  v_mov_b32_dpp v41, v79 row_newbcast:2 row_mask:0xf bank_mask:0x3
  v_mov_b32_dpp v41, v79 row_newbcast:10 row_mask:0xf bank_mask:0xc
  v_and_b32 v16, v41, v4
L_hop496:
  s_cbranch_execz L_hop520
  v_and_b32 v17, v41, v5
  v_and_b32 v18, v41, v6
  v_and_b32 v19, v41, v7
  s_nop 1
  v_mfma_f32_16x16x32_bf16 v[60:63], v[108:111], v[16:19], v[60:63]
  buffer_load_dwordx4 v[156:159], v1, s[44:47], s68 offen offset:1024 nt
  s_waitcnt vmcnt(11)
  v_mov_b32_dpp v45, v76 row_newbcast:3 row_mask:0xf bank_mask:0x3
  v_mov_b32_dpp v45, v76 row_newbcast:11 row_mask:0xf bank_mask:0xc
  v_and_b32 v12, v45, v4
  v_and_b32 v13, v45, v5
  v_and_b32 v14, v45, v6
  v_and_b32 v15, v45, v7
  s_nop 1
  v_mfma_f32_16x16x32_bf16 v[48:51], v[112:115], v[12:15], v[48:51]
  v_mov_b32_dpp v41, v77 row_newbcast:3 row_mask:0xf bank_mask:0x3
  v_mov_b32_dpp v41, v77 row_newbcast:11 row_mask:0xf bank_mask:0xc
  v_and_b32 v16, v41, v4
  v_and_b32 v17, v41, v5
  v_and_b32 v18, v41, v6
  v_and_b32 v19, v41, v7
  s_nop 1
  v_mfma_f32_16x16x32_bf16 v[52:55], v[112:115], v[16:19], v[52:55]
L_hop520:
  s_cbranch_execz L_hop543
  v_mov_b32_dpp v45, v78 row_newbcast:3 row_mask:0xf bank_mask:0x3
  v_mov_b32_dpp v45, v78 row_newbcast:11 row_mask:0xf bank_mask:0xc
  v_and_b32 v12, v45, v4
  v_and_b32 v13, v45, v5
  v_and_b32 v14, v45, v6
  v_and_b32 v15, v45, v7
  s_nop 1
  v_mfma_f32_16x16x32_bf16 v[56:59], v[112:115], v[12:15], v[56:59]
  v_mov_b32_dpp v41, v79 row_newbcast:3 row_mask:0xf bank_mask:0x3
  v_mov_b32_dpp v41, v79 row_newbcast:11 row_mask:0xf bank_mask:0xc
  v_and_b32 v16, v41, v4
  v_and_b32 v17, v41, v5
  v_and_b32 v18, v41, v6
  v_and_b32 v19, v41, v7
  s_nop 1
  v_mfma_f32_16x16x32_bf16 v[60:63], v[112:115], v[16:19], v[60:63]
  buffer_load_dwordx4 v[160:163], v1, s[44:47], s68 offen offset:2048 nt
  s_waitcnt vmcnt(11)
  v_mov_b32_dpp v45, v76 row_newbcast:4 row_mask:0xf bank_mask:0x3
  v_mov_b32_dpp v45, v76 row_newbcast:12 row_mask:0xf bank_mask:0xc
  v_and_b32 v12, v45, v4
  v_and_b32 v13, v45, v5
L_hop543:
  s_cbranch_execz L_hop566
  v_and_b32 v14, v45, v6
  v_and_b32 v15, v45, v7
  s_nop 1
  v_mfma_f32_16x16x32_bf16 v[48:51], v[116:119], v[12:15], v[48:51]
  v_mov_b32_dpp v41, v77 row_newbcast:4 row_mask:0xf bank_mask:0x3
  v_mov_b32_dpp v41, v77 row_newbcast:12 row_mask:0xf bank_mask:0xc
  v_and_b32 v16, v41, v4
  v_and_b32 v17, v41, v5
  v_and_b32 v18, v41, v6
  v_and_b32 v19, v41, v7
  s_nop 1
  v_mfma_f32_16x16x32_bf16 v[52:55], v[116:119], v[16:19], v[52:55]
  v_mov_b32_dpp v45, v78 row_newbcast:4 row_mask:0xf bank_mask:0x3
  v_mov_b32_dpp v45, v78 row_newbcast:12 row_mask:0xf bank_mask:0xc
  v_and_b32 v12, v45, v4
  v_and_b32 v13, v45, v5
  v_and_b32 v14, v45, v6
  v_and_b32 v15, v45, v7
  s_nop 1
  v_mfma_f32_16x16x32_bf16 v[56:59], v[116:119], v[12:15], v[56:59]
  v_mov_b32_dpp v41, v79 row_newbcast:4 row_mask:0xf bank_mask:0x3
  v_mov_b32_dpp v41, v79 row_newbcast:12 row_mask:0xf bank_mask:0xc
L_hop566:
  s_cbranch_execz L_hop595
  v_and_b32 v16, v41, v4
  v_and_b32 v17, v41, v5
  v_and_b32 v18, v41, v6
  v_and_b32 v19, v41, v7
  s_nop 1
  v_mfma_f32_16x16x32_bf16 v[60:63], v[116:119], v[16:19], v[60:63]
  buffer_load_dwordx4 v[164:167], v1, s[44:47], s68 offen offset:3072 nt
  s_add_u32 s68, s68, 16384
  v_mov_b32 v41, 0
  v_mov_b32 v45, 1
  s_mov_b64 exec, s[98:99]
  ds_write_b32 v37, v48 offset:4096
  ds_write_b32 v37, v49 offset:4128
  ds_write_b32 v37, v50 offset:4160
  ds_write_b32 v37, v51 offset:4192
  ds_write_b32 v37, v52 offset:4352
  ds_write_b32 v37, v53 offset:4384
  ds_write_b32 v37, v54 offset:4416
  ds_write_b32 v37, v55 offset:4448
  ds_write_b32 v37, v56 offset:4608
  ds_write_b32 v37, v57 offset:4640
  ds_write_b32 v37, v58 offset:4672
  ds_write_b32 v37, v59 offset:4704
  ds_write_b32 v37, v60 offset:4864
  ds_write_b32 v37, v61 offset:4896
  ds_write_b32 v37, v62 offset:4928
  ds_write_b32 v37, v63 offset:4960
  s_mov_b64 exec, 1
L_hop595:
  s_cbranch_execz L_wret3
  ds_add_u32 v41, v45 offset:0
  s_mov_b64 exec, -1
  v_mov_b32 v41, 0
  s_mov_b32 s97, 0
  s_nop 9
L_sp2:
  ds_read_b32 v44, v41 offset:28
  s_add_u32 s97, s97, 1
  s_waitcnt lgkmcnt(0)
  v_cmp_le_u32 vcc, 1, v44
  s_cbranch_vccnz L_ok1
  s_cmp_gt_u32 s97, 4000000
  s_cbranch_scc1 L_ok1
  s_sleep 1
  s_branch L_sp2
L_wseg3_3:
L_hop611:
  s_cbranch_execz L_hop631
  s_nop 9
L_ok1:
  v_readfirstlane_b32 s28, v44
  s_nop 0
  s_mul_i32 s100, s28, 0x9e3779b1
  s_bfe_u32 s24, s100, 524288
  s_bfe_u32 s25, s100, 524296
  s_bfe_u32 s26, s100, 524304
  s_bfe_u32 s27, s100, 524312
  s_waitcnt vmcnt(10)
  buffer_load_dwordx4 v[168:171], v1, s[44:47], s68 offen offset:0 nt
  buffer_load_dwordx4 v[172:175], v1, s[44:47], s68 offen offset:1024 nt
  s_waitcnt vmcnt(10)
  buffer_load_dwordx4 v[176:179], v1, s[44:47], s68 offen offset:2048 nt
  buffer_load_dwordx4 v[180:183], v1, s[44:47], s68 offen offset:3072 nt
  s_add_u32 s68, s68, 16384
  s_waitcnt vmcnt(10)
  buffer_load_dwordx4 v[184:187], v1, s[44:47], s68 offen offset:0 nt
  buffer_load_dwordx4 v[188:191], v1, s[44:47], s68 offen offset:1024 nt
L_hop631:
  s_cbranch_execz L_hop662
  s_waitcnt vmcnt(10)
  buffer_load_dwordx4 v[192:195], v1, s[44:47], s68 offen offset:2048 nt
  buffer_load_dwordx4 v[196:199], v1, s[44:47], s68 offen offset:3072 nt
  s_add_u32 s68, s68, 16384
  s_waitcnt vmcnt(10)
L_gl4:
  s_memrealtime s[30:31]
  s_waitcnt lgkmcnt(0)
  s_sub_u32 s29, s30, s28
  s_cmp_lt_u32 s29, 422
  s_cbranch_scc0 L_gk3
  s_sleep 1
  s_branch L_gl4
L_gk3:
  buffer_load_dwordx4 v[200:203], v1, s[44:47], s68 offen offset:0 nt
  buffer_load_dwordx4 v[204:207], v1, s[44:47], s68 offen offset:1024 nt
  s_waitcnt vmcnt(10)
  buffer_load_dwordx4 v[208:211], v1, s[44:47], s68 offen offset:2048 nt
  buffer_load_dwordx4 v[212:215], v1, s[44:47], s68 offen offset:3072 nt
  s_add_u32 s68, s68, 16384
  s_waitcnt vmcnt(10)
L_gl6:
  s_memrealtime s[30:31]
  s_waitcnt lgkmcnt(0)
  s_sub_u32 s29, s30, s28
  s_cmp_lt_u32 s29, 479
  s_cbranch_scc0 L_gk5
  s_sleep 1
  s_branch L_gl6
L_gk5:
L_hop662:
  s_cbranch_execz L_hop680
  buffer_load_dwordx4 v[216:219], v1, s[44:47], s68 offen offset:0 nt
  buffer_load_dwordx4 v[220:223], v1, s[44:47], s68 offen offset:1024 nt
  s_waitcnt vmcnt(10)
  buffer_load_dwordx4 v[224:227], v1, s[44:47], s68 offen offset:2048 nt
  buffer_load_dwordx4 v[228:231], v1, s[44:47], s68 offen offset:3072 nt
  s_add_u32 s68, s68, 16384
  s_waitcnt vmcnt(10)
L_gl8:
  s_memrealtime s[30:31]
  s_waitcnt lgkmcnt(0)
  s_sub_u32 s29, s30, s28
  s_cmp_lt_u32 s29, 536
  s_cbranch_scc0 L_gk7
  s_sleep 1
  s_branch L_gl8
L_gk7:
  buffer_load_dwordx4 v[232:235], v1, s[44:47], s68 offen offset:0 nt
L_hop680:
  s_cbranch_execz L_hop712
  buffer_load_dwordx4 v[236:239], v1, s[44:47], s68 offen offset:1024 nt
  s_waitcnt vmcnt(10)
  buffer_load_dwordx4 v[240:243], v1, s[44:47], s68 offen offset:2048 nt
  buffer_load_dwordx4 v[244:247], v1, s[44:47], s68 offen offset:3072 nt
  s_add_u32 s68, s68, 16384
  s_waitcnt vmcnt(10)
L_gl10:
  s_memrealtime s[30:31]
  s_waitcnt lgkmcnt(0)
  s_sub_u32 s29, s30, s28
  s_cmp_lt_u32 s29, 593
  s_cbranch_scc0 L_gk9
  s_sleep 1
  s_branch L_gl10
L_gk9:
  buffer_load_dwordx4 v[248:251], v1, s[44:47], s68 offen offset:0 nt
  buffer_load_dwordx4 v[252:255], v1, s[44:47], s68 offen offset:1024 nt
  s_waitcnt vmcnt(10)
  buffer_load_dwordx4 v[80:83], v1, s[44:47], s68 offen offset:2048 nt
  buffer_load_dwordx4 v[84:87], v1, s[44:47], s68 offen offset:3072 nt
  s_add_u32 s68, s68, 16384
  s_waitcnt vmcnt(10)
L_gl12:
  s_memrealtime s[30:31]
  s_waitcnt lgkmcnt(0)
  s_sub_u32 s29, s30, s28
  s_cmp_lt_u32 s29, 650
  s_cbranch_scc0 L_gk11
  s_sleep 1
  s_branch L_gl12
L_gk11:
L_hop712:
  s_cbranch_execz L_hop730
  buffer_load_dwordx4 v[88:91], v1, s[44:47], s68 offen offset:0 nt
  buffer_load_dwordx4 v[92:95], v1, s[44:47], s68 offen offset:1024 nt
  s_waitcnt vmcnt(10)
  buffer_load_dwordx4 v[96:99], v1, s[44:47], s68 offen offset:2048 nt
  buffer_load_dwordx4 v[100:103], v1, s[44:47], s68 offen offset:3072 nt
  s_add_u32 s68, s68, 16384
  s_waitcnt vmcnt(10)
L_gl14:
  s_memrealtime s[30:31]
  s_waitcnt lgkmcnt(0)
  s_sub_u32 s29, s30, s28
  s_cmp_lt_u32 s29, 707
  s_cbranch_scc0 L_gk13
  s_sleep 1
  s_branch L_gl14
L_gk13:
  buffer_load_dwordx4 v[104:107], v1, s[44:47], s68 offen offset:0 nt
L_hop730:
  s_cbranch_execz L_hop755
  buffer_load_dwordx4 v[108:111], v1, s[44:47], s68 offen offset:1024 nt
  s_waitcnt vmcnt(10)
  buffer_load_dwordx4 v[112:115], v1, s[44:47], s68 offen offset:2048 nt
  buffer_load_dwordx4 v[116:119], v1, s[44:47], s68 offen offset:3072 nt
  s_add_u32 s68, s68, 16384
  v_mov_b32 v41, 0
  s_mov_b32 s97, 0
  s_nop 9
L_sp16:
  ds_read_b32 v44, v41 offset:16
  s_add_u32 s97, s97, 1
  s_waitcnt lgkmcnt(0)
  v_cmp_le_u32 vcc, 1, v44
  s_cbranch_vccnz L_ok15
  s_cmp_gt_u32 s97, 4000000
  s_cbranch_scc1 L_ok15
  s_sleep 1
  s_branch L_sp16
  s_nop 9
L_ok15:
  v_lshlrev_b32 v44, 4, v43
  ds_read_b128 v[8:11], v44 offset:256
  ds_read_b32 v45, v41 offset:128
  v_mov_b32 v24, 0xff7fffff
L_hop755:
  s_cbranch_execz L_wret3
  v_mov_b32 v25, 0
  s_waitcnt lgkmcnt(0)
  v_readfirstlane_b32 s77, v45
  s_nop 0
  s_add_u32 s28, s28, s77
L_wseg0:
L_hop761:
  s_cbranch_execz L_hop788
  v_dot2_f32_bf16 v30, v120, v8, 0
  v_dot2_f32_bf16 v31, v124, v8, 0
  v_dot2_f32_bf16 v32, v128, v8, 0
  v_dot2_f32_bf16 v33, v132, v8, 0
  v_dot2c_f32_bf16 v30, v121, v9
  v_dot2c_f32_bf16 v31, v125, v9
  v_dot2c_f32_bf16 v32, v129, v9
  v_dot2c_f32_bf16 v33, v133, v9
  v_dot2c_f32_bf16 v30, v122, v10
  v_dot2c_f32_bf16 v31, v126, v10
  v_dot2c_f32_bf16 v32, v130, v10
  v_dot2c_f32_bf16 v33, v134, v10
  v_dot2c_f32_bf16 v30, v123, v11
  v_dot2c_f32_bf16 v31, v127, v11
  v_dot2c_f32_bf16 v32, v131, v11
  v_dot2c_f32_bf16 v33, v135, v11
  s_waitcnt vmcnt(8)
L_gl18:
  s_memrealtime s[30:31]
  s_waitcnt lgkmcnt(0)
  s_sub_u32 s29, s30, s28
  s_cmp_lt_u32 s29, 764
  s_cbranch_scc0 L_gk17
  s_sleep 1
  s_branch L_gl18
L_gk17:
L_hop788:
  s_cbranch_execz L_hop802
  buffer_load_dwordx4 v[120:123], v1, s[44:47], s68 offen offset:0 nt
  v_add_f32_dpp v34, v30, v30 row_ror:8 row_mask:0xf bank_mask:0x3
  v_add_f32_dpp v34, v31, v31 row_ror:8 row_mask:0xf bank_mask:0xc
  v_add_f32_dpp v35, v32, v32 row_ror:8 row_mask:0xf bank_mask:0x3
  v_add_f32_dpp v35, v33, v33 row_ror:8 row_mask:0xf bank_mask:0xc
  buffer_load_dwordx4 v[124:127], v1, s[44:47], s68 offen offset:1024 nt
  v_add_f32_dpp v36, v34, v34 row_ror:12 row_mask:0xf bank_mask:0x5
  v_add_f32_dpp v36, v35, v35 row_ror:4 row_mask:0xf bank_mask:0xa
  buffer_load_dwordx4 v[128:131], v1, s[44:47], s68 offen offset:2048 nt
  buffer_load_dwordx4 v[132:135], v1, s[44:47], s68 offen offset:3072 nt
  s_add_u32 s68, s68, 16384
  v_add_f32_dpp v36, v36, v36 quad_perm:[2,3,0,1] row_mask:0xf bank_mask:0xf
  s_nop 1
L_hop802:
  s_cbranch_execz L_hop830
  v_add_f32_dpp v48, v36, v36 quad_perm:[1,0,3,2] row_mask:0xf bank_mask:0xf
  v_dot2_f32_bf16 v30, v136, v8, 0
  v_dot2_f32_bf16 v31, v140, v8, 0
  v_dot2_f32_bf16 v32, v144, v8, 0
  v_dot2_f32_bf16 v33, v148, v8, 0
  v_dot2c_f32_bf16 v30, v137, v9
  v_dot2c_f32_bf16 v31, v141, v9
  v_dot2c_f32_bf16 v32, v145, v9
  v_dot2c_f32_bf16 v33, v149, v9
  v_dot2c_f32_bf16 v30, v138, v10
  v_dot2c_f32_bf16 v31, v142, v10
  v_dot2c_f32_bf16 v32, v146, v10
  v_dot2c_f32_bf16 v33, v150, v10
  v_dot2c_f32_bf16 v30, v139, v11
  v_dot2c_f32_bf16 v31, v143, v11
  v_dot2c_f32_bf16 v32, v147, v11
  v_dot2c_f32_bf16 v33, v151, v11
  s_waitcnt vmcnt(8)
L_gl20:
  s_memrealtime s[30:31]
  s_waitcnt lgkmcnt(0)
  s_sub_u32 s29, s30, s28
  s_cmp_lt_u32 s29, 828
  s_cbranch_scc0 L_gk19
  s_sleep 1
  s_branch L_gl20
L_gk19:
L_hop830:
  s_cbranch_execz L_hop848
  buffer_load_dwordx4 v[136:139], v1, s[44:47], s68 offen offset:0 nt
  v_add_f32_dpp v34, v30, v30 row_ror:8 row_mask:0xf bank_mask:0x3
  v_add_f32_dpp v34, v31, v31 row_ror:8 row_mask:0xf bank_mask:0xc
  v_add_f32_dpp v35, v32, v32 row_ror:8 row_mask:0xf bank_mask:0x3
  v_add_f32_dpp v35, v33, v33 row_ror:8 row_mask:0xf bank_mask:0xc
  buffer_load_dwordx4 v[140:143], v1, s[44:47], s68 offen offset:1024 nt
  v_add_f32_dpp v36, v34, v34 row_ror:12 row_mask:0xf bank_mask:0x5
  v_add_f32_dpp v36, v35, v35 row_ror:4 row_mask:0xf bank_mask:0xa
  buffer_load_dwordx4 v[144:147], v1, s[44:47], s68 offen offset:2048 nt
  buffer_load_dwordx4 v[148:151], v1, s[44:47], s68 offen offset:3072 nt
  s_add_u32 s68, s68, 16384
  v_cvt_pk_bf16_f32 v37, v48, v48
  v_and_b32 v37, s80, v37
  v_mul_f32 v37, s79, v37
  v_cvt_pk_bf16_f32 v37, v37, v37
  v_and_b32 v48, s80, v37
  v_max_f32 v24, v24, v48
L_hop848:
  s_cbranch_execz L_hop878
  v_add_f32_dpp v36, v36, v36 quad_perm:[2,3,0,1] row_mask:0xf bank_mask:0xf
  s_nop 1
  v_add_f32_dpp v49, v36, v36 quad_perm:[1,0,3,2] row_mask:0xf bank_mask:0xf
  v_dot2_f32_bf16 v30, v152, v8, 0
  v_dot2_f32_bf16 v31, v156, v8, 0
  v_dot2_f32_bf16 v32, v160, v8, 0
  v_dot2_f32_bf16 v33, v164, v8, 0
  v_dot2c_f32_bf16 v30, v153, v9
  v_dot2c_f32_bf16 v31, v157, v9
  v_dot2c_f32_bf16 v32, v161, v9
  v_dot2c_f32_bf16 v33, v165, v9
  v_dot2c_f32_bf16 v30, v154, v10
  v_dot2c_f32_bf16 v31, v158, v10
  v_dot2c_f32_bf16 v32, v162, v10
  v_dot2c_f32_bf16 v33, v166, v10
  v_dot2c_f32_bf16 v30, v155, v11
  v_dot2c_f32_bf16 v31, v159, v11
  v_dot2c_f32_bf16 v32, v163, v11
  v_dot2c_f32_bf16 v33, v167, v11
  s_waitcnt vmcnt(8)
L_gl22:
  s_memrealtime s[30:31]
  s_waitcnt lgkmcnt(0)
  s_sub_u32 s29, s30, s28
  s_cmp_lt_u32 s29, 893
  s_cbranch_scc0 L_gk21
  s_sleep 1
  s_branch L_gl22
L_gk21:
L_hop878:
  s_cbranch_execz L_hop894
  buffer_load_dwordx4 v[152:155], v1, s[44:47], s68 offen offset:0 nt
  v_add_f32_dpp v34, v30, v30 row_ror:8 row_mask:0xf bank_mask:0x3
  v_add_f32_dpp v34, v31, v31 row_ror:8 row_mask:0xf bank_mask:0xc
  v_add_f32_dpp v35, v32, v32 row_ror:8 row_mask:0xf bank_mask:0x3
  v_add_f32_dpp v35, v33, v33 row_ror:8 row_mask:0xf bank_mask:0xc
  buffer_load_dwordx4 v[156:159], v1, s[44:47], s68 offen offset:1024 nt
  v_add_f32_dpp v36, v34, v34 row_ror:12 row_mask:0xf bank_mask:0x5
  v_add_f32_dpp v36, v35, v35 row_ror:4 row_mask:0xf bank_mask:0xa
  buffer_load_dwordx4 v[160:163], v1, s[44:47], s68 offen offset:2048 nt
  buffer_load_dwordx4 v[164:167], v1, s[44:47], s68 offen offset:3072 nt
  s_add_u32 s68, s68, 16384
  v_cvt_pk_bf16_f32 v37, v49, v49
  v_and_b32 v37, s80, v37
  v_mul_f32 v37, s79, v37
  v_cvt_pk_bf16_f32 v37, v37, v37
L_hop894:
  s_cbranch_execz L_hop925
  v_and_b32 v49, s80, v37
  v_max_f32 v24, v24, v49
  v_add_f32_dpp v36, v36, v36 quad_perm:[2,3,0,1] row_mask:0xf bank_mask:0xf
  s_nop 1
  v_add_f32_dpp v50, v36, v36 quad_perm:[1,0,3,2] row_mask:0xf bank_mask:0xf
  v_dot2_f32_bf16 v30, v168, v8, 0
  v_dot2_f32_bf16 v31, v172, v8, 0
  v_dot2_f32_bf16 v32, v176, v8, 0
  v_dot2_f32_bf16 v33, v180, v8, 0
  v_dot2c_f32_bf16 v30, v169, v9
  v_dot2c_f32_bf16 v31, v173, v9
  v_dot2c_f32_bf16 v32, v177, v9
  v_dot2c_f32_bf16 v33, v181, v9
  v_dot2c_f32_bf16 v30, v170, v10
  v_dot2c_f32_bf16 v31, v174, v10
  v_dot2c_f32_bf16 v32, v178, v10
  v_dot2c_f32_bf16 v33, v182, v10
  v_dot2c_f32_bf16 v30, v171, v11
  v_dot2c_f32_bf16 v31, v175, v11
  v_dot2c_f32_bf16 v32, v179, v11
  v_dot2c_f32_bf16 v33, v183, v11
L_gl24:
  s_memrealtime s[30:31]
  s_waitcnt lgkmcnt(0)
  s_sub_u32 s29, s30, s28
  s_cmp_lt_u32 s29, 957
  s_cbranch_scc0 L_gk23
  s_sleep 1
  s_branch L_gl24
L_gk23:
L_hop925:
  s_cbranch_execz L_hop939
  buffer_load_dwordx4 v[168:171], v1, s[44:47], s68 offen offset:0 nt
  v_add_f32_dpp v34, v30, v30 row_ror:8 row_mask:0xf bank_mask:0x3
  v_add_f32_dpp v34, v31, v31 row_ror:8 row_mask:0xf bank_mask:0xc
  v_add_f32_dpp v35, v32, v32 row_ror:8 row_mask:0xf bank_mask:0x3
  v_add_f32_dpp v35, v33, v33 row_ror:8 row_mask:0xf bank_mask:0xc
  buffer_load_dwordx4 v[172:175], v1, s[44:47], s68 offen offset:1024 nt
  v_add_f32_dpp v36, v34, v34 row_ror:12 row_mask:0xf bank_mask:0x5
  v_add_f32_dpp v36, v35, v35 row_ror:4 row_mask:0xf bank_mask:0xa
  buffer_load_dwordx4 v[176:179], v1, s[44:47], s68 offen offset:2048 nt
  buffer_load_dwordx4 v[180:183], v1, s[44:47], s68 offen offset:3072 nt
  s_add_u32 s68, s68, 16384
  v_cvt_pk_bf16_f32 v37, v50, v50
  v_and_b32 v37, s80, v37
L_hop939:
  s_cbranch_execz L_hop964
  v_mul_f32 v37, s79, v37
  v_cvt_pk_bf16_f32 v37, v37, v37
  v_and_b32 v50, s80, v37
  v_max_f32 v24, v24, v50
  v_add_f32_dpp v36, v36, v36 quad_perm:[2,3,0,1] row_mask:0xf bank_mask:0xf
  s_nop 1
  v_add_f32_dpp v51, v36, v36 quad_perm:[1,0,3,2] row_mask:0xf bank_mask:0xf
  v_dot2_f32_bf16 v30, v184, v8, 0
  v_dot2_f32_bf16 v31, v188, v8, 0
  v_dot2_f32_bf16 v32, v192, v8, 0
  v_dot2_f32_bf16 v33, v196, v8, 0
  v_dot2c_f32_bf16 v30, v185, v9
  v_dot2c_f32_bf16 v31, v189, v9
  v_dot2c_f32_bf16 v32, v193, v9
  v_dot2c_f32_bf16 v33, v197, v9
  v_dot2c_f32_bf16 v30, v186, v10
  v_dot2c_f32_bf16 v31, v190, v10
  v_dot2c_f32_bf16 v32, v194, v10
  v_dot2c_f32_bf16 v33, v198, v10
  v_dot2c_f32_bf16 v30, v187, v11
  v_dot2c_f32_bf16 v31, v191, v11
  v_dot2c_f32_bf16 v32, v195, v11
  v_dot2c_f32_bf16 v33, v199, v11
  v_add_f32_dpp v34, v30, v30 row_ror:8 row_mask:0xf bank_mask:0x3
L_hop964:
  s_cbranch_execz L_hop983
  v_add_f32_dpp v34, v31, v31 row_ror:8 row_mask:0xf bank_mask:0xc
  v_add_f32_dpp v35, v32, v32 row_ror:8 row_mask:0xf bank_mask:0x3
  v_add_f32_dpp v35, v33, v33 row_ror:8 row_mask:0xf bank_mask:0xc
  v_add_f32_dpp v36, v34, v34 row_ror:12 row_mask:0xf bank_mask:0x5
  s_nop 0
  v_add_f32_dpp v36, v35, v35 row_ror:4 row_mask:0xf bank_mask:0xa
  v_cvt_pk_bf16_f32 v37, v51, v51
  v_and_b32 v37, s80, v37
  v_mul_f32 v37, s79, v37
  v_cvt_pk_bf16_f32 v37, v37, v37
  v_and_b32 v51, s80, v37
  v_max_f32 v24, v24, v51
  v_add_f32_dpp v36, v36, v36 quad_perm:[2,3,0,1] row_mask:0xf bank_mask:0xf
  s_nop 1
  v_add_f32_dpp v52, v36, v36 quad_perm:[1,0,3,2] row_mask:0xf bank_mask:0xf
  v_dot2_f32_bf16 v30, v200, v8, 0
  v_dot2_f32_bf16 v31, v204, v8, 0
  v_dot2_f32_bf16 v32, v208, v8, 0
L_hop983:
  s_cbranch_execz L_hop1007
  v_dot2_f32_bf16 v33, v212, v8, 0
  v_dot2c_f32_bf16 v30, v201, v9
  v_dot2c_f32_bf16 v31, v205, v9
  v_dot2c_f32_bf16 v32, v209, v9
  v_dot2c_f32_bf16 v33, v213, v9
  v_dot2c_f32_bf16 v30, v202, v10
  v_dot2c_f32_bf16 v31, v206, v10
  v_dot2c_f32_bf16 v32, v210, v10
  v_dot2c_f32_bf16 v33, v214, v10
  v_dot2c_f32_bf16 v30, v203, v11
  v_dot2c_f32_bf16 v31, v207, v11
  v_dot2c_f32_bf16 v32, v211, v11
  v_dot2c_f32_bf16 v33, v215, v11
  v_add_f32_dpp v34, v30, v30 row_ror:8 row_mask:0xf bank_mask:0x3
  v_add_f32_dpp v34, v31, v31 row_ror:8 row_mask:0xf bank_mask:0xc
  v_add_f32_dpp v35, v32, v32 row_ror:8 row_mask:0xf bank_mask:0x3
  v_add_f32_dpp v35, v33, v33 row_ror:8 row_mask:0xf bank_mask:0xc
  v_add_f32_dpp v36, v34, v34 row_ror:12 row_mask:0xf bank_mask:0x5
  s_nop 0
  v_add_f32_dpp v36, v35, v35 row_ror:4 row_mask:0xf bank_mask:0xa
  v_cvt_pk_bf16_f32 v37, v52, v52
  v_and_b32 v37, s80, v37
  v_mul_f32 v37, s79, v37
L_hop1007:
  s_cbranch_execz L_hop1040
  v_cvt_pk_bf16_f32 v37, v37, v37
  v_and_b32 v52, s80, v37
  v_max_f32 v24, v24, v52
  v_add_f32_dpp v36, v36, v36 quad_perm:[2,3,0,1] row_mask:0xf bank_mask:0xf
  s_nop 1
  v_add_f32_dpp v53, v36, v36 quad_perm:[1,0,3,2] row_mask:0xf bank_mask:0xf
  v_dot2_f32_bf16 v30, v216, v8, 0
  v_dot2_f32_bf16 v31, v220, v8, 0
  v_dot2_f32_bf16 v32, v224, v8, 0
  v_dot2_f32_bf16 v33, v228, v8, 0
  v_dot2c_f32_bf16 v30, v217, v9
  v_dot2c_f32_bf16 v31, v221, v9
  v_dot2c_f32_bf16 v32, v225, v9
  v_dot2c_f32_bf16 v33, v229, v9
  v_dot2c_f32_bf16 v30, v218, v10
  v_dot2c_f32_bf16 v31, v222, v10
  v_dot2c_f32_bf16 v32, v226, v10
  v_dot2c_f32_bf16 v33, v230, v10
  v_dot2c_f32_bf16 v30, v219, v11
  v_dot2c_f32_bf16 v31, v223, v11
  v_dot2c_f32_bf16 v32, v227, v11
  v_dot2c_f32_bf16 v33, v231, v11
  s_waitcnt vmcnt(12)
L_gl26:
  s_memrealtime s[30:31]
  s_waitcnt lgkmcnt(0)
  s_sub_u32 s29, s30, s28
  s_cmp_lt_u32 s29, 1022
  s_cbranch_scc0 L_gk25
  s_sleep 1
  s_branch L_gl26
L_gk25:
L_hop1040:
  s_cbranch_execz L_hop1053
  buffer_load_dwordx4 v[184:187], v1, s[44:47], s68 offen offset:0 nt
  v_add_f32_dpp v34, v30, v30 row_ror:8 row_mask:0xf bank_mask:0x3
  v_add_f32_dpp v34, v31, v31 row_ror:8 row_mask:0xf bank_mask:0xc
  v_add_f32_dpp v35, v32, v32 row_ror:8 row_mask:0xf bank_mask:0x3
  v_add_f32_dpp v35, v33, v33 row_ror:8 row_mask:0xf bank_mask:0xc
  buffer_load_dwordx4 v[188:191], v1, s[44:47], s68 offen offset:1024 nt
  v_add_f32_dpp v36, v34, v34 row_ror:12 row_mask:0xf bank_mask:0x5
  v_add_f32_dpp v36, v35, v35 row_ror:4 row_mask:0xf bank_mask:0xa
  buffer_load_dwordx4 v[192:195], v1, s[44:47], s68 offen offset:2048 nt
  buffer_load_dwordx4 v[196:199], v1, s[44:47], s68 offen offset:3072 nt
  s_add_u32 s68, s68, 16384
  v_cvt_pk_bf16_f32 v37, v53, v53
L_hop1053:
  s_cbranch_execz L_hop1077
  v_and_b32 v37, s80, v37
  v_mul_f32 v37, s79, v37
  v_cvt_pk_bf16_f32 v37, v37, v37
  v_and_b32 v53, s80, v37
  v_max_f32 v24, v24, v53
  v_add_f32_dpp v36, v36, v36 quad_perm:[2,3,0,1] row_mask:0xf bank_mask:0xf
  s_nop 1
  v_add_f32_dpp v54, v36, v36 quad_perm:[1,0,3,2] row_mask:0xf bank_mask:0xf
  v_dot2_f32_bf16 v30, v232, v8, 0
  v_dot2_f32_bf16 v31, v236, v8, 0
  v_dot2_f32_bf16 v32, v240, v8, 0
  v_dot2_f32_bf16 v33, v244, v8, 0
  v_dot2c_f32_bf16 v30, v233, v9
  v_dot2c_f32_bf16 v31, v237, v9
  v_dot2c_f32_bf16 v32, v241, v9
  v_dot2c_f32_bf16 v33, v245, v9
  v_dot2c_f32_bf16 v30, v234, v10
  v_dot2c_f32_bf16 v31, v238, v10
  v_dot2c_f32_bf16 v32, v242, v10
  v_dot2c_f32_bf16 v33, v246, v10
  v_dot2c_f32_bf16 v30, v235, v11
  v_dot2c_f32_bf16 v31, v239, v11
  v_dot2c_f32_bf16 v32, v243, v11
L_hop1077:
  s_cbranch_execz L_hop1097
  v_dot2c_f32_bf16 v33, v247, v11
  v_add_f32_dpp v34, v30, v30 row_ror:8 row_mask:0xf bank_mask:0x3
  v_add_f32_dpp v34, v31, v31 row_ror:8 row_mask:0xf bank_mask:0xc
  v_add_f32_dpp v35, v32, v32 row_ror:8 row_mask:0xf bank_mask:0x3
  v_add_f32_dpp v35, v33, v33 row_ror:8 row_mask:0xf bank_mask:0xc
  v_add_f32_dpp v36, v34, v34 row_ror:12 row_mask:0xf bank_mask:0x5
  s_nop 0
  v_add_f32_dpp v36, v35, v35 row_ror:4 row_mask:0xf bank_mask:0xa
  v_cvt_pk_bf16_f32 v37, v54, v54
  v_and_b32 v37, s80, v37
  v_mul_f32 v37, s79, v37
  v_cvt_pk_bf16_f32 v37, v37, v37
  v_and_b32 v54, s80, v37
  v_max_f32 v24, v24, v54
  v_add_f32_dpp v36, v36, v36 quad_perm:[2,3,0,1] row_mask:0xf bank_mask:0xf
  s_nop 1
  v_add_f32_dpp v55, v36, v36 quad_perm:[1,0,3,2] row_mask:0xf bank_mask:0xf
  v_dot2_f32_bf16 v30, v248, v8, 0
  v_dot2_f32_bf16 v31, v252, v8, 0
L_hop1097:
  s_cbranch_execz L_hop1120
  v_dot2_f32_bf16 v32, v80, v8, 0
  v_dot2_f32_bf16 v33, v84, v8, 0
  v_dot2c_f32_bf16 v30, v249, v9
  v_dot2c_f32_bf16 v31, v253, v9
  v_dot2c_f32_bf16 v32, v81, v9
  v_dot2c_f32_bf16 v33, v85, v9
  v_dot2c_f32_bf16 v30, v250, v10
  v_dot2c_f32_bf16 v31, v254, v10
  v_dot2c_f32_bf16 v32, v82, v10
  v_dot2c_f32_bf16 v33, v86, v10
  v_dot2c_f32_bf16 v30, v251, v11
  v_dot2c_f32_bf16 v31, v255, v11
  v_dot2c_f32_bf16 v32, v83, v11
  v_dot2c_f32_bf16 v33, v87, v11
  v_add_f32_dpp v34, v30, v30 row_ror:8 row_mask:0xf bank_mask:0x3
  v_add_f32_dpp v34, v31, v31 row_ror:8 row_mask:0xf bank_mask:0xc
  v_add_f32_dpp v35, v32, v32 row_ror:8 row_mask:0xf bank_mask:0x3
  v_add_f32_dpp v35, v33, v33 row_ror:8 row_mask:0xf bank_mask:0xc
  v_add_f32_dpp v36, v34, v34 row_ror:12 row_mask:0xf bank_mask:0x5
  s_nop 0
  v_add_f32_dpp v36, v35, v35 row_ror:4 row_mask:0xf bank_mask:0xa
  v_cvt_pk_bf16_f32 v37, v55, v55
L_hop1120:
  s_cbranch_execz L_hop1139
  v_and_b32 v37, s80, v37
  v_mul_f32 v37, s79, v37
  v_cvt_pk_bf16_f32 v37, v37, v37
  v_and_b32 v55, s80, v37
  v_max_f32 v24, v24, v55
  v_add_f32_dpp v36, v36, v36 quad_perm:[2,3,0,1] row_mask:0xf bank_mask:0xf
  s_nop 1
  v_add_f32_dpp v56, v36, v36 quad_perm:[1,0,3,2] row_mask:0xf bank_mask:0xf
  buffer_load_dwordx4 v[200:203], v39, s[8:11], s93 offen nt
  s_add_u32 s93, s93, 5120
  buffer_load_dwordx4 v[204:207], v39, s[8:11], s93 offen nt
  s_add_u32 s93, s93, 5120
  buffer_load_dwordx4 v[208:211], v39, s[8:11], s93 offen nt
  s_add_u32 s93, s93, 5120
  buffer_load_dwordx4 v[212:215], v39, s[8:11], s93 offen nt
  v_dot2_f32_bf16 v30, v88, v8, 0
  v_dot2_f32_bf16 v31, v92, v8, 0
  v_dot2_f32_bf16 v32, v96, v8, 0
L_hop1139:
  s_cbranch_execz L_hop1163
  v_dot2_f32_bf16 v33, v100, v8, 0
  v_dot2c_f32_bf16 v30, v89, v9
  v_dot2c_f32_bf16 v31, v93, v9
  v_dot2c_f32_bf16 v32, v97, v9
  v_dot2c_f32_bf16 v33, v101, v9
  v_dot2c_f32_bf16 v30, v90, v10
  v_dot2c_f32_bf16 v31, v94, v10
  v_dot2c_f32_bf16 v32, v98, v10
  v_dot2c_f32_bf16 v33, v102, v10
  v_dot2c_f32_bf16 v30, v91, v11
  v_dot2c_f32_bf16 v31, v95, v11
  v_dot2c_f32_bf16 v32, v99, v11
  v_dot2c_f32_bf16 v33, v103, v11
  v_add_f32_dpp v34, v30, v30 row_ror:8 row_mask:0xf bank_mask:0x3
  v_add_f32_dpp v34, v31, v31 row_ror:8 row_mask:0xf bank_mask:0xc
  v_add_f32_dpp v35, v32, v32 row_ror:8 row_mask:0xf bank_mask:0x3
  v_add_f32_dpp v35, v33, v33 row_ror:8 row_mask:0xf bank_mask:0xc
  v_add_f32_dpp v36, v34, v34 row_ror:12 row_mask:0xf bank_mask:0x5
  s_nop 0
  v_add_f32_dpp v36, v35, v35 row_ror:4 row_mask:0xf bank_mask:0xa
  v_cvt_pk_bf16_f32 v37, v56, v56
  v_and_b32 v37, s80, v37
  v_mul_f32 v37, s79, v37
L_hop1163:
  s_cbranch_execz L_hop1196
  v_cvt_pk_bf16_f32 v37, v37, v37
  v_and_b32 v56, s80, v37
  v_max_f32 v24, v24, v56
  v_add_f32_dpp v36, v36, v36 quad_perm:[2,3,0,1] row_mask:0xf bank_mask:0xf
  s_nop 1
  v_add_f32_dpp v57, v36, v36 quad_perm:[1,0,3,2] row_mask:0xf bank_mask:0xf
  v_dot2_f32_bf16 v30, v104, v8, 0
  v_dot2_f32_bf16 v31, v108, v8, 0
  v_dot2_f32_bf16 v32, v112, v8, 0
  v_dot2_f32_bf16 v33, v116, v8, 0
  v_dot2c_f32_bf16 v30, v105, v9
  v_dot2c_f32_bf16 v31, v109, v9
  v_dot2c_f32_bf16 v32, v113, v9
  v_dot2c_f32_bf16 v33, v117, v9
  v_dot2c_f32_bf16 v30, v106, v10
  v_dot2c_f32_bf16 v31, v110, v10
  v_dot2c_f32_bf16 v32, v114, v10
  v_dot2c_f32_bf16 v33, v118, v10
  v_dot2c_f32_bf16 v30, v107, v11
  v_dot2c_f32_bf16 v31, v111, v11
  v_dot2c_f32_bf16 v32, v115, v11
  v_dot2c_f32_bf16 v33, v119, v11
  s_waitcnt vmcnt(16)
L_gl28:
  s_memrealtime s[30:31]
  s_waitcnt lgkmcnt(0)
  s_sub_u32 s29, s30, s28
  s_cmp_lt_u32 s29, 1079
  s_cbranch_scc0 L_gk27
  s_sleep 1
  s_branch L_gl28
L_gk27:
L_hop1196:
  s_cbranch_execz L_hop1209
  buffer_load_dwordx4 v[216:219], v1, s[44:47], s68 offen offset:0 nt
  v_add_f32_dpp v34, v30, v30 row_ror:8 row_mask:0xf bank_mask:0x3
  v_add_f32_dpp v34, v31, v31 row_ror:8 row_mask:0xf bank_mask:0xc
  v_add_f32_dpp v35, v32, v32 row_ror:8 row_mask:0xf bank_mask:0x3
  v_add_f32_dpp v35, v33, v33 row_ror:8 row_mask:0xf bank_mask:0xc
  buffer_load_dwordx4 v[220:223], v1, s[44:47], s68 offen offset:1024 nt
  v_add_f32_dpp v36, v34, v34 row_ror:12 row_mask:0xf bank_mask:0x5
  v_add_f32_dpp v36, v35, v35 row_ror:4 row_mask:0xf bank_mask:0xa
  buffer_load_dwordx4 v[224:227], v1, s[44:47], s68 offen offset:2048 nt
  buffer_load_dwordx4 v[228:231], v1, s[44:47], s68 offen offset:3072 nt
  s_add_u32 s68, s68, 16384
  v_cvt_pk_bf16_f32 v37, v57, v57
L_hop1209:
  s_cbranch_execz L_hop1233
  v_and_b32 v37, s80, v37
  v_mul_f32 v37, s79, v37
  v_cvt_pk_bf16_f32 v37, v37, v37
  v_and_b32 v57, s80, v37
  v_max_f32 v24, v24, v57
  v_add_f32_dpp v36, v36, v36 quad_perm:[2,3,0,1] row_mask:0xf bank_mask:0xf
  s_nop 1
  v_add_f32_dpp v58, v36, v36 quad_perm:[1,0,3,2] row_mask:0xf bank_mask:0xf
  v_dot2_f32_bf16 v30, v120, v8, 0
  v_dot2_f32_bf16 v31, v124, v8, 0
  v_dot2_f32_bf16 v32, v128, v8, 0
  v_dot2_f32_bf16 v33, v132, v8, 0
  v_dot2c_f32_bf16 v30, v121, v9
  v_dot2c_f32_bf16 v31, v125, v9
  v_dot2c_f32_bf16 v32, v129, v9
  v_dot2c_f32_bf16 v33, v133, v9
  v_dot2c_f32_bf16 v30, v122, v10
  v_dot2c_f32_bf16 v31, v126, v10
  v_dot2c_f32_bf16 v32, v130, v10
  v_dot2c_f32_bf16 v33, v134, v10
  v_dot2c_f32_bf16 v30, v123, v11
  v_dot2c_f32_bf16 v31, v127, v11
  v_dot2c_f32_bf16 v32, v131, v11
L_hop1233:
  s_cbranch_execz L_hop1253
  v_dot2c_f32_bf16 v33, v135, v11
  v_add_f32_dpp v34, v30, v30 row_ror:8 row_mask:0xf bank_mask:0x3
  v_add_f32_dpp v34, v31, v31 row_ror:8 row_mask:0xf bank_mask:0xc
  v_add_f32_dpp v35, v32, v32 row_ror:8 row_mask:0xf bank_mask:0x3
  v_add_f32_dpp v35, v33, v33 row_ror:8 row_mask:0xf bank_mask:0xc
  v_add_f32_dpp v36, v34, v34 row_ror:12 row_mask:0xf bank_mask:0x5
  s_nop 0
  v_add_f32_dpp v36, v35, v35 row_ror:4 row_mask:0xf bank_mask:0xa
  v_cvt_pk_bf16_f32 v37, v58, v58
  v_and_b32 v37, s80, v37
  v_mul_f32 v37, s79, v37
  v_cvt_pk_bf16_f32 v37, v37, v37
  v_and_b32 v58, s80, v37
  v_max_f32 v24, v24, v58
  v_add_f32_dpp v36, v36, v36 quad_perm:[2,3,0,1] row_mask:0xf bank_mask:0xf
  s_nop 1
  v_add_f32_dpp v59, v36, v36 quad_perm:[1,0,3,2] row_mask:0xf bank_mask:0xf
  v_dot2_f32_bf16 v30, v136, v8, 0
  v_dot2_f32_bf16 v31, v140, v8, 0
L_hop1253:
  s_cbranch_execz L_hop1276
  v_dot2_f32_bf16 v32, v144, v8, 0
  v_dot2_f32_bf16 v33, v148, v8, 0
  v_dot2c_f32_bf16 v30, v137, v9
  v_dot2c_f32_bf16 v31, v141, v9
  v_dot2c_f32_bf16 v32, v145, v9
  v_dot2c_f32_bf16 v33, v149, v9
  v_dot2c_f32_bf16 v30, v138, v10
  v_dot2c_f32_bf16 v31, v142, v10
  v_dot2c_f32_bf16 v32, v146, v10
  v_dot2c_f32_bf16 v33, v150, v10
  v_dot2c_f32_bf16 v30, v139, v11
  v_dot2c_f32_bf16 v31, v143, v11
  v_dot2c_f32_bf16 v32, v147, v11
  v_dot2c_f32_bf16 v33, v151, v11
  v_add_f32_dpp v34, v30, v30 row_ror:8 row_mask:0xf bank_mask:0x3
  v_add_f32_dpp v34, v31, v31 row_ror:8 row_mask:0xf bank_mask:0xc
  v_add_f32_dpp v35, v32, v32 row_ror:8 row_mask:0xf bank_mask:0x3
  v_add_f32_dpp v35, v33, v33 row_ror:8 row_mask:0xf bank_mask:0xc
  v_add_f32_dpp v36, v34, v34 row_ror:12 row_mask:0xf bank_mask:0x5
  s_nop 0
  v_add_f32_dpp v36, v35, v35 row_ror:4 row_mask:0xf bank_mask:0xa
  v_cvt_pk_bf16_f32 v37, v59, v59
L_hop1276:
  s_cbranch_execz L_hop1301
  v_and_b32 v37, s80, v37
  v_mul_f32 v37, s79, v37
  v_cvt_pk_bf16_f32 v37, v37, v37
  v_and_b32 v59, s80, v37
  v_max_f32 v24, v24, v59
  v_add_f32_dpp v36, v36, v36 quad_perm:[2,3,0,1] row_mask:0xf bank_mask:0xf
  s_nop 1
  v_add_f32_dpp v60, v36, v36 quad_perm:[1,0,3,2] row_mask:0xf bank_mask:0xf
  s_waitcnt vmcnt(16)
  v_dot2_f32_bf16 v30, v152, v8, 0
  v_dot2_f32_bf16 v31, v156, v8, 0
  v_dot2_f32_bf16 v32, v160, v8, 0
  v_dot2_f32_bf16 v33, v164, v8, 0
  v_dot2c_f32_bf16 v30, v153, v9
  v_dot2c_f32_bf16 v31, v157, v9
  v_dot2c_f32_bf16 v32, v161, v9
  v_dot2c_f32_bf16 v33, v165, v9
  v_dot2c_f32_bf16 v30, v154, v10
  v_dot2c_f32_bf16 v31, v158, v10
  v_dot2c_f32_bf16 v32, v162, v10
  v_dot2c_f32_bf16 v33, v166, v10
  v_dot2c_f32_bf16 v30, v155, v11
  v_dot2c_f32_bf16 v31, v159, v11
  v_dot2c_f32_bf16 v32, v163, v11
L_hop1301:
  s_cbranch_execz L_hop1323
  v_dot2c_f32_bf16 v33, v167, v11
L_gl30:
  s_memrealtime s[30:31]
  s_waitcnt lgkmcnt(0)
  s_sub_u32 s29, s30, s28
  s_cmp_lt_u32 s29, 1136
  s_cbranch_scc0 L_gk29
  s_sleep 1
  s_branch L_gl30
L_gk29:
  buffer_load_dwordx4 v[232:235], v1, s[44:47], s68 offen offset:0 nt
  v_add_f32_dpp v34, v30, v30 row_ror:8 row_mask:0xf bank_mask:0x3
  v_add_f32_dpp v34, v31, v31 row_ror:8 row_mask:0xf bank_mask:0xc
  v_add_f32_dpp v35, v32, v32 row_ror:8 row_mask:0xf bank_mask:0x3
  v_add_f32_dpp v35, v33, v33 row_ror:8 row_mask:0xf bank_mask:0xc
  buffer_load_dwordx4 v[236:239], v1, s[44:47], s68 offen offset:1024 nt
  v_add_f32_dpp v36, v34, v34 row_ror:12 row_mask:0xf bank_mask:0x5
  v_add_f32_dpp v36, v35, v35 row_ror:4 row_mask:0xf bank_mask:0xa
  buffer_load_dwordx4 v[240:243], v1, s[44:47], s68 offen offset:2048 nt
  buffer_load_dwordx4 v[244:247], v1, s[44:47], s68 offen offset:3072 nt
  s_add_u32 s68, s68, 16384
L_hop1323:
  s_cbranch_execz L_wret0
  v_cvt_pk_bf16_f32 v37, v60, v60
  v_and_b32 v37, s80, v37
  v_mul_f32 v37, s79, v37
  v_cvt_pk_bf16_f32 v37, v37, v37
  v_and_b32 v60, s80, v37
  v_max_f32 v24, v24, v60
  v_add_f32_dpp v36, v36, v36 quad_perm:[2,3,0,1] row_mask:0xf bank_mask:0xf
  s_nop 1
  v_add_f32_dpp v61, v36, v36 quad_perm:[1,0,3,2] row_mask:0xf bank_mask:0xf
L_wseg1:
L_hop1333:
  s_cbranch_execz L_hop1346
  s_waitcnt vmcnt(16)
  v_dot2_f32_bf16 v30, v168, v8, 0
  v_dot2_f32_bf16 v31, v172, v8, 0
  v_dot2_f32_bf16 v32, v176, v8, 0
  v_dot2_f32_bf16 v33, v180, v8, 0
  v_dot2c_f32_bf16 v30, v169, v9
  v_dot2c_f32_bf16 v31, v173, v9
  v_dot2c_f32_bf16 v32, v177, v9
  v_dot2c_f32_bf16 v33, v181, v9
  v_dot2c_f32_bf16 v30, v170, v10
  v_dot2c_f32_bf16 v31, v174, v10
  v_dot2c_f32_bf16 v32, v178, v10
L_hop1346:
  s_cbranch_execz L_hop1370
  v_dot2c_f32_bf16 v33, v182, v10
  v_dot2c_f32_bf16 v30, v171, v11
  v_dot2c_f32_bf16 v31, v175, v11
  v_dot2c_f32_bf16 v32, v179, v11
  v_dot2c_f32_bf16 v33, v183, v11
L_gl32:
  s_memrealtime s[30:31]
  s_waitcnt lgkmcnt(0)
  s_sub_u32 s29, s30, s28
  s_cmp_lt_u32 s29, 1193
  s_cbranch_scc0 L_gk31
  s_sleep 1
  s_branch L_gl32
L_gk31:
  buffer_load_dwordx4 v[248:251], v1, s[44:47], s68 offen offset:0 nt
  v_add_f32_dpp v34, v30, v30 row_ror:8 row_mask:0xf bank_mask:0x3
  v_add_f32_dpp v34, v31, v31 row_ror:8 row_mask:0xf bank_mask:0xc
  v_add_f32_dpp v35, v32, v32 row_ror:8 row_mask:0xf bank_mask:0x3
  v_add_f32_dpp v35, v33, v33 row_ror:8 row_mask:0xf bank_mask:0xc
  buffer_load_dwordx4 v[252:255], v1, s[44:47], s68 offen offset:1024 nt
  v_add_f32_dpp v36, v34, v34 row_ror:12 row_mask:0xf bank_mask:0x5
  v_add_f32_dpp v36, v35, v35 row_ror:4 row_mask:0xf bank_mask:0xa
  buffer_load_dwordx4 v[80:83], v1, s[44:47], s68 offen offset:2048 nt
L_hop1370:
  s_cbranch_execz L_hop1391
  buffer_load_dwordx4 v[84:87], v1, s[44:47], s68 offen offset:3072 nt
  s_add_u32 s68, s68, 16384
  v_cvt_pk_bf16_f32 v37, v61, v61
  v_and_b32 v37, s80, v37
  v_mul_f32 v37, s79, v37
  v_cvt_pk_bf16_f32 v37, v37, v37
  v_and_b32 v61, s80, v37
  v_max_f32 v24, v24, v61
  v_add_f32_dpp v36, v36, v36 quad_perm:[2,3,0,1] row_mask:0xf bank_mask:0xf
  s_nop 1
  v_add_f32_dpp v62, v36, v36 quad_perm:[1,0,3,2] row_mask:0xf bank_mask:0xf
  s_waitcnt vmcnt(16)
  v_dot2_f32_bf16 v30, v184, v8, 0
  v_dot2_f32_bf16 v31, v188, v8, 0
  v_dot2_f32_bf16 v32, v192, v8, 0
  v_dot2_f32_bf16 v33, v196, v8, 0
  v_dot2c_f32_bf16 v30, v185, v9
  v_dot2c_f32_bf16 v31, v189, v9
  v_dot2c_f32_bf16 v32, v193, v9
  v_dot2c_f32_bf16 v33, v197, v9
L_hop1391:
  s_cbranch_execz L_hop1416
  v_dot2c_f32_bf16 v30, v186, v10
  v_dot2c_f32_bf16 v31, v190, v10
  v_dot2c_f32_bf16 v32, v194, v10
  v_dot2c_f32_bf16 v33, v198, v10
  v_dot2c_f32_bf16 v30, v187, v11
  v_dot2c_f32_bf16 v31, v191, v11
  v_dot2c_f32_bf16 v32, v195, v11
  v_dot2c_f32_bf16 v33, v199, v11
L_gl34:
  s_memrealtime s[30:31]
  s_waitcnt lgkmcnt(0)
  s_sub_u32 s29, s30, s28
  s_cmp_lt_u32 s29, 1250
  s_cbranch_scc0 L_gk33
  s_sleep 1
  s_branch L_gl34
L_gk33:
  buffer_load_dwordx4 v[88:91], v1, s[44:47], s68 offen offset:0 nt
  v_add_f32_dpp v34, v30, v30 row_ror:8 row_mask:0xf bank_mask:0x3
  v_add_f32_dpp v34, v31, v31 row_ror:8 row_mask:0xf bank_mask:0xc
  v_add_f32_dpp v35, v32, v32 row_ror:8 row_mask:0xf bank_mask:0x3
  v_add_f32_dpp v35, v33, v33 row_ror:8 row_mask:0xf bank_mask:0xc
  buffer_load_dwordx4 v[92:95], v1, s[44:47], s68 offen offset:1024 nt
  v_add_f32_dpp v36, v34, v34 row_ror:12 row_mask:0xf bank_mask:0x5
L_hop1416:
  s_cbranch_execz L_hop1436
  v_add_f32_dpp v36, v35, v35 row_ror:4 row_mask:0xf bank_mask:0xa
  buffer_load_dwordx4 v[96:99], v1, s[44:47], s68 offen offset:2048 nt
  buffer_load_dwordx4 v[100:103], v1, s[44:47], s68 offen offset:3072 nt
  s_add_u32 s68, s68, 16384
  v_cvt_pk_bf16_f32 v37, v62, v62
  v_and_b32 v37, s80, v37
  v_mul_f32 v37, s79, v37
  v_cvt_pk_bf16_f32 v37, v37, v37
  v_and_b32 v62, s80, v37
  v_max_f32 v24, v24, v62
  v_add_f32_dpp v36, v36, v36 quad_perm:[2,3,0,1] row_mask:0xf bank_mask:0xf
  s_nop 1
  v_add_f32_dpp v63, v36, v36 quad_perm:[1,0,3,2] row_mask:0xf bank_mask:0xf
  s_waitcnt vmcnt(12)
  v_dot2_f32_bf16 v30, v216, v8, 0
  v_dot2_f32_bf16 v31, v220, v8, 0
  v_dot2_f32_bf16 v32, v224, v8, 0
  v_dot2_f32_bf16 v33, v228, v8, 0
  v_dot2c_f32_bf16 v30, v217, v9
L_hop1436:
  s_cbranch_execz L_hop1463
  v_dot2c_f32_bf16 v31, v221, v9
  v_dot2c_f32_bf16 v32, v225, v9
  v_dot2c_f32_bf16 v33, v229, v9
  v_dot2c_f32_bf16 v30, v218, v10
  v_dot2c_f32_bf16 v31, v222, v10
  v_dot2c_f32_bf16 v32, v226, v10
  v_dot2c_f32_bf16 v33, v230, v10
  v_dot2c_f32_bf16 v30, v219, v11
  v_dot2c_f32_bf16 v31, v223, v11
  v_dot2c_f32_bf16 v32, v227, v11
  v_dot2c_f32_bf16 v33, v231, v11
L_gl36:
  s_memrealtime s[30:31]
  s_waitcnt lgkmcnt(0)
  s_sub_u32 s29, s30, s28
  s_cmp_lt_u32 s29, 1307
  s_cbranch_scc0 L_gk35
  s_sleep 1
  s_branch L_gl36
L_gk35:
  buffer_load_dwordx4 v[104:107], v1, s[44:47], s68 offen offset:0 nt
  v_add_f32_dpp v34, v30, v30 row_ror:8 row_mask:0xf bank_mask:0x3
  v_add_f32_dpp v34, v31, v31 row_ror:8 row_mask:0xf bank_mask:0xc
  v_add_f32_dpp v35, v32, v32 row_ror:8 row_mask:0xf bank_mask:0x3
  v_add_f32_dpp v35, v33, v33 row_ror:8 row_mask:0xf bank_mask:0xc
  buffer_load_dwordx4 v[108:111], v1, s[44:47], s68 offen offset:1024 nt
L_hop1463:
  s_cbranch_execz L_hop1491
  v_add_f32_dpp v36, v34, v34 row_ror:12 row_mask:0xf bank_mask:0x5
  v_add_f32_dpp v36, v35, v35 row_ror:4 row_mask:0xf bank_mask:0xa
  buffer_load_dwordx4 v[112:115], v1, s[44:47], s68 offen offset:2048 nt
  buffer_load_dwordx4 v[116:119], v1, s[44:47], s68 offen offset:3072 nt
  s_add_u32 s68, s68, 16384
  v_cvt_pk_bf16_f32 v37, v63, v63
  v_and_b32 v37, s80, v37
  v_mul_f32 v37, s79, v37
  v_cvt_pk_bf16_f32 v37, v37, v37
  v_and_b32 v63, s80, v37
  v_max_f32 v24, v24, v63
  v_add_f32_dpp v36, v36, v36 quad_perm:[2,3,0,1] row_mask:0xf bank_mask:0xf
  s_nop 1
  v_add_f32_dpp v64, v36, v36 quad_perm:[1,0,3,2] row_mask:0xf bank_mask:0xf
  v_mov_b32 v41, 0
  s_mov_b32 s97, 0
  s_nop 9
L_sp38:
  ds_read_b32 v44, v41 offset:20
  s_add_u32 s97, s97, 1
  s_waitcnt lgkmcnt(0)
  v_cmp_le_u32 vcc, 1, v44
  s_cbranch_vccnz L_ok37
  s_cmp_gt_u32 s97, 4000000
  s_cbranch_scc1 L_ok37
  s_sleep 1
  s_branch L_sp38
L_hop1491:
  s_cbranch_execz L_hop1511
  s_nop 9
L_ok37:
  s_lshl_b32 s77, s3, 8
  v_lshl_add_u32 v41, v42, 6, s77
  ds_read_b128 v[228:231], v41 offset:512
  ds_read_b128 v[224:227], v41 offset:528
  ds_read_b128 v[220:223], v41 offset:544
  ds_read_b128 v[216:219], v41 offset:560
  s_lshl_b32 s77, s3, 11
  v_add_u32 v44, s77, v47
  s_waitcnt lgkmcnt(0)
  v_and_b32 v12, v228, v4
  v_and_b32 v13, v228, v5
  v_and_b32 v14, v228, v6
  v_and_b32 v15, v228, v7
  s_nop 1
  v_mfma_f32_16x16x32_bf16 v[196:199], v[200:203], v[12:15], 0
  v_and_b32 v16, v224, v4
  v_and_b32 v17, v224, v5
L_hop1511:
  s_cbranch_execz L_hop1539
  v_and_b32 v18, v224, v6
  v_and_b32 v19, v224, v7
  s_nop 1
  v_mfma_f32_16x16x32_bf16 v[192:195], v[200:203], v[16:19], 0
  v_and_b32 v12, v220, v4
  v_and_b32 v13, v220, v5
  v_and_b32 v14, v220, v6
  v_and_b32 v15, v220, v7
  s_nop 1
  v_mfma_f32_16x16x32_bf16 v[188:191], v[200:203], v[12:15], 0
  v_and_b32 v16, v216, v4
  v_and_b32 v17, v216, v5
  v_and_b32 v18, v216, v6
  v_and_b32 v19, v216, v7
  s_nop 1
  v_mfma_f32_16x16x32_bf16 v[184:187], v[200:203], v[16:19], 0
  v_and_b32 v12, v229, v4
  v_and_b32 v13, v229, v5
  v_and_b32 v14, v229, v6
  v_and_b32 v15, v229, v7
  s_nop 1
  v_mfma_f32_16x16x32_bf16 v[196:199], v[204:207], v[12:15], v[196:199]
  v_and_b32 v16, v225, v4
  v_and_b32 v17, v225, v5
  v_and_b32 v18, v225, v6
  v_and_b32 v19, v225, v7
  s_nop 1
L_hop1539:
  s_cbranch_execz L_hop1566
  v_mfma_f32_16x16x32_bf16 v[192:195], v[204:207], v[16:19], v[192:195]
  v_and_b32 v12, v221, v4
  v_and_b32 v13, v221, v5
  v_and_b32 v14, v221, v6
  v_and_b32 v15, v221, v7
  s_nop 1
  v_mfma_f32_16x16x32_bf16 v[188:191], v[204:207], v[12:15], v[188:191]
  v_and_b32 v16, v217, v4
  v_and_b32 v17, v217, v5
  v_and_b32 v18, v217, v6
  v_and_b32 v19, v217, v7
  s_nop 1
  v_mfma_f32_16x16x32_bf16 v[184:187], v[204:207], v[16:19], v[184:187]
  v_and_b32 v12, v230, v4
  v_and_b32 v13, v230, v5
  v_and_b32 v14, v230, v6
  v_and_b32 v15, v230, v7
  s_nop 1
  v_mfma_f32_16x16x32_bf16 v[196:199], v[208:211], v[12:15], v[196:199]
  v_and_b32 v16, v226, v4
  v_and_b32 v17, v226, v5
  v_and_b32 v18, v226, v6
  v_and_b32 v19, v226, v7
  s_nop 1
  v_mfma_f32_16x16x32_bf16 v[192:195], v[208:211], v[16:19], v[192:195]
  v_and_b32 v12, v222, v4
L_hop1566:
  s_cbranch_execz L_hop1594
  v_and_b32 v13, v222, v5
  v_and_b32 v14, v222, v6
  v_and_b32 v15, v222, v7
  s_nop 1
  v_mfma_f32_16x16x32_bf16 v[188:191], v[208:211], v[12:15], v[188:191]
  v_and_b32 v16, v218, v4
  v_and_b32 v17, v218, v5
  v_and_b32 v18, v218, v6
  v_and_b32 v19, v218, v7
  s_nop 1
  v_mfma_f32_16x16x32_bf16 v[184:187], v[208:211], v[16:19], v[184:187]
  v_and_b32 v12, v231, v4
  v_and_b32 v13, v231, v5
  v_and_b32 v14, v231, v6
  v_and_b32 v15, v231, v7
  s_nop 1
  v_mfma_f32_16x16x32_bf16 v[196:199], v[212:215], v[12:15], v[196:199]
  v_and_b32 v16, v227, v4
  v_and_b32 v17, v227, v5
  v_and_b32 v18, v227, v6
  v_and_b32 v19, v227, v7
  s_nop 1
  v_mfma_f32_16x16x32_bf16 v[192:195], v[212:215], v[16:19], v[192:195]
  v_and_b32 v12, v223, v4
  v_and_b32 v13, v223, v5
  v_and_b32 v14, v223, v6
  v_and_b32 v15, v223, v7
L_hop1594:
  s_cbranch_execz L_hop1614
  s_nop 1
  v_mfma_f32_16x16x32_bf16 v[188:191], v[212:215], v[12:15], v[188:191]
  v_and_b32 v16, v219, v4
  v_and_b32 v17, v219, v5
  v_and_b32 v18, v219, v6
  v_and_b32 v19, v219, v7
  s_nop 1
  v_mfma_f32_16x16x32_bf16 v[184:187], v[212:215], v[16:19], v[184:187]
  ds_write_b32 v44, v196 offset:4096
  ds_write_b32 v44, v197 offset:4128
  ds_write_b32 v44, v198 offset:4160
  ds_write_b32 v44, v199 offset:4192
  ds_write_b32 v44, v192 offset:4608
  ds_write_b32 v44, v193 offset:4640
  ds_write_b32 v44, v194 offset:4672
  ds_write_b32 v44, v195 offset:4704
  ds_write_b32 v44, v188 offset:5120
  ds_write_b32 v44, v189 offset:5152
  ds_write_b32 v44, v190 offset:5184
L_hop1614:
  s_cbranch_execz L_hop1635
  ds_write_b32 v44, v191 offset:5216
  ds_write_b32 v44, v184 offset:5632
  ds_write_b32 v44, v185 offset:5664
  ds_write_b32 v44, v186 offset:5696
  ds_write_b32 v44, v187 offset:5728
  v_mov_b32 v41, 0
  v_mov_b32 v45, 1
  s_mov_b64 exec, 1
  ds_add_u32 v41, v45 offset:8
  s_mov_b64 exec, -1
  s_waitcnt lgkmcnt(0)
  s_waitcnt vmcnt(12)
  v_dot2_f32_bf16 v30, v232, v8, 0
  v_dot2_f32_bf16 v31, v236, v8, 0
  v_dot2_f32_bf16 v32, v240, v8, 0
  v_dot2_f32_bf16 v33, v244, v8, 0
  v_dot2c_f32_bf16 v30, v233, v9
  v_dot2c_f32_bf16 v31, v237, v9
  v_dot2c_f32_bf16 v32, v241, v9
  v_dot2c_f32_bf16 v33, v245, v9
L_hop1635:
  s_cbranch_execz L_hop1660
  v_dot2c_f32_bf16 v30, v234, v10
  v_dot2c_f32_bf16 v31, v238, v10
  v_dot2c_f32_bf16 v32, v242, v10
  v_dot2c_f32_bf16 v33, v246, v10
  v_dot2c_f32_bf16 v30, v235, v11
  v_dot2c_f32_bf16 v31, v239, v11
  v_dot2c_f32_bf16 v32, v243, v11
  v_dot2c_f32_bf16 v33, v247, v11
L_gl40:
  s_memrealtime s[30:31]
  s_waitcnt lgkmcnt(0)
  s_sub_u32 s29, s30, s28
  s_cmp_lt_u32 s29, 1364
  s_cbranch_scc0 L_gk39
  s_sleep 1
  s_branch L_gl40
L_gk39:
  buffer_load_dwordx4 v[120:123], v1, s[44:47], s68 offen offset:0 nt
  v_add_f32_dpp v34, v30, v30 row_ror:8 row_mask:0xf bank_mask:0x3
  v_add_f32_dpp v34, v31, v31 row_ror:8 row_mask:0xf bank_mask:0xc
  v_add_f32_dpp v35, v32, v32 row_ror:8 row_mask:0xf bank_mask:0x3
  v_add_f32_dpp v35, v33, v33 row_ror:8 row_mask:0xf bank_mask:0xc
  buffer_load_dwordx4 v[124:127], v1, s[44:47], s68 offen offset:1024 nt
  v_add_f32_dpp v36, v34, v34 row_ror:12 row_mask:0xf bank_mask:0x5
L_hop1660:
  s_cbranch_execz L_hop1680
  v_add_f32_dpp v36, v35, v35 row_ror:4 row_mask:0xf bank_mask:0xa
  buffer_load_dwordx4 v[128:131], v1, s[44:47], s68 offen offset:2048 nt
  buffer_load_dwordx4 v[132:135], v1, s[44:47], s68 offen offset:3072 nt
  s_add_u32 s68, s68, 16384
  v_cvt_pk_bf16_f32 v37, v64, v64
  v_and_b32 v37, s80, v37
  v_mul_f32 v37, s79, v37
  v_cvt_pk_bf16_f32 v37, v37, v37
  v_and_b32 v64, s80, v37
  v_max_f32 v24, v24, v64
  v_add_f32_dpp v36, v36, v36 quad_perm:[2,3,0,1] row_mask:0xf bank_mask:0xf
  s_nop 1
  v_add_f32_dpp v65, v36, v36 quad_perm:[1,0,3,2] row_mask:0xf bank_mask:0xf
  s_waitcnt vmcnt(12)
  v_dot2_f32_bf16 v30, v248, v8, 0
  v_dot2_f32_bf16 v31, v252, v8, 0
  v_dot2_f32_bf16 v32, v80, v8, 0
  v_dot2_f32_bf16 v33, v84, v8, 0
  v_dot2c_f32_bf16 v30, v249, v9
L_hop1680:
  s_cbranch_execz L_hop1707
  v_dot2c_f32_bf16 v31, v253, v9
  v_dot2c_f32_bf16 v32, v81, v9
  v_dot2c_f32_bf16 v33, v85, v9
  v_dot2c_f32_bf16 v30, v250, v10
  v_dot2c_f32_bf16 v31, v254, v10
  v_dot2c_f32_bf16 v32, v82, v10
  v_dot2c_f32_bf16 v33, v86, v10
  v_dot2c_f32_bf16 v30, v251, v11
  v_dot2c_f32_bf16 v31, v255, v11
  v_dot2c_f32_bf16 v32, v83, v11
  v_dot2c_f32_bf16 v33, v87, v11
L_gl42:
  s_memrealtime s[30:31]
  s_waitcnt lgkmcnt(0)
  s_sub_u32 s29, s30, s28
  s_cmp_lt_u32 s29, 1421
  s_cbranch_scc0 L_gk41
  s_sleep 1
  s_branch L_gl42
L_gk41:
  buffer_load_dwordx4 v[136:139], v1, s[44:47], s68 offen offset:0 nt
  v_add_f32_dpp v34, v30, v30 row_ror:8 row_mask:0xf bank_mask:0x3
  v_add_f32_dpp v34, v31, v31 row_ror:8 row_mask:0xf bank_mask:0xc
  v_add_f32_dpp v35, v32, v32 row_ror:8 row_mask:0xf bank_mask:0x3
  v_add_f32_dpp v35, v33, v33 row_ror:8 row_mask:0xf bank_mask:0xc
  buffer_load_dwordx4 v[140:143], v1, s[44:47], s68 offen offset:1024 nt
L_hop1707:
  s_cbranch_execz L_hop1726
  v_add_f32_dpp v36, v34, v34 row_ror:12 row_mask:0xf bank_mask:0x5
  v_add_f32_dpp v36, v35, v35 row_ror:4 row_mask:0xf bank_mask:0xa
  buffer_load_dwordx4 v[144:147], v1, s[44:47], s68 offen offset:2048 nt
  buffer_load_dwordx4 v[148:151], v1, s[44:47], s68 offen offset:3072 nt
  s_add_u32 s68, s68, 16384
  v_cvt_pk_bf16_f32 v37, v65, v65
  v_and_b32 v37, s80, v37
  v_mul_f32 v37, s79, v37
  v_cvt_pk_bf16_f32 v37, v37, v37
  v_and_b32 v65, s80, v37
  v_max_f32 v24, v24, v65
  v_add_f32_dpp v36, v36, v36 quad_perm:[2,3,0,1] row_mask:0xf bank_mask:0xf
  s_nop 1
  v_add_f32_dpp v66, v36, v36 quad_perm:[1,0,3,2] row_mask:0xf bank_mask:0xf
  s_waitcnt vmcnt(12)
  v_dot2_f32_bf16 v30, v88, v8, 0
  v_dot2_f32_bf16 v31, v92, v8, 0
  v_dot2_f32_bf16 v32, v96, v8, 0
L_hop1726:
  s_cbranch_execz L_hop1753
  v_dot2_f32_bf16 v33, v100, v8, 0
  v_dot2c_f32_bf16 v30, v89, v9
  v_dot2c_f32_bf16 v31, v93, v9
  v_dot2c_f32_bf16 v32, v97, v9
  v_dot2c_f32_bf16 v33, v101, v9
  v_dot2c_f32_bf16 v30, v90, v10
  v_dot2c_f32_bf16 v31, v94, v10
  v_dot2c_f32_bf16 v32, v98, v10
  v_dot2c_f32_bf16 v33, v102, v10
  v_dot2c_f32_bf16 v30, v91, v11
  v_dot2c_f32_bf16 v31, v95, v11
  v_dot2c_f32_bf16 v32, v99, v11
  v_dot2c_f32_bf16 v33, v103, v11
L_gl44:
  s_memrealtime s[30:31]
  s_waitcnt lgkmcnt(0)
  s_sub_u32 s29, s30, s28
  s_cmp_lt_u32 s29, 1478
  s_cbranch_scc0 L_gk43
  s_sleep 1
  s_branch L_gl44
L_gk43:
  buffer_load_dwordx4 v[152:155], v1, s[44:47], s68 offen offset:0 nt
  v_add_f32_dpp v34, v30, v30 row_ror:8 row_mask:0xf bank_mask:0x3
  v_add_f32_dpp v34, v31, v31 row_ror:8 row_mask:0xf bank_mask:0xc
  v_add_f32_dpp v35, v32, v32 row_ror:8 row_mask:0xf bank_mask:0x3
L_hop1753:
  s_cbranch_execz L_hop1773
  v_add_f32_dpp v35, v33, v33 row_ror:8 row_mask:0xf bank_mask:0xc
  buffer_load_dwordx4 v[156:159], v1, s[44:47], s68 offen offset:1024 nt
  v_add_f32_dpp v36, v34, v34 row_ror:12 row_mask:0xf bank_mask:0x5
  v_add_f32_dpp v36, v35, v35 row_ror:4 row_mask:0xf bank_mask:0xa
  buffer_load_dwordx4 v[160:163], v1, s[44:47], s68 offen offset:2048 nt
  buffer_load_dwordx4 v[164:167], v1, s[44:47], s68 offen offset:3072 nt
  s_add_u32 s68, s68, 16384
  v_cvt_pk_bf16_f32 v37, v66, v66
  v_and_b32 v37, s80, v37
  v_mul_f32 v37, s79, v37
  v_cvt_pk_bf16_f32 v37, v37, v37
  v_and_b32 v66, s80, v37
  v_max_f32 v24, v24, v66
  v_add_f32_dpp v36, v36, v36 quad_perm:[2,3,0,1] row_mask:0xf bank_mask:0xf
  s_nop 1
  v_add_f32_dpp v67, v36, v36 quad_perm:[1,0,3,2] row_mask:0xf bank_mask:0xf
  s_waitcnt vmcnt(12)
  v_dot2_f32_bf16 v30, v104, v8, 0
  v_dot2_f32_bf16 v31, v108, v8, 0
L_hop1773:
  s_cbranch_execz L_hop1800
  v_dot2_f32_bf16 v32, v112, v8, 0
  v_dot2_f32_bf16 v33, v116, v8, 0
  v_dot2c_f32_bf16 v30, v105, v9
  v_dot2c_f32_bf16 v31, v109, v9
  v_dot2c_f32_bf16 v32, v113, v9
  v_dot2c_f32_bf16 v33, v117, v9
  v_dot2c_f32_bf16 v30, v106, v10
  v_dot2c_f32_bf16 v31, v110, v10
  v_dot2c_f32_bf16 v32, v114, v10
  v_dot2c_f32_bf16 v33, v118, v10
  v_dot2c_f32_bf16 v30, v107, v11
  v_dot2c_f32_bf16 v31, v111, v11
  v_dot2c_f32_bf16 v32, v115, v11
  v_dot2c_f32_bf16 v33, v119, v11
L_gl46:
  s_memrealtime s[30:31]
  s_waitcnt lgkmcnt(0)
  s_sub_u32 s29, s30, s28
  s_cmp_lt_u32 s29, 1535
  s_cbranch_scc0 L_gk45
  s_sleep 1
  s_branch L_gl46
L_gk45:
  buffer_load_dwordx4 v[168:171], v1, s[44:47], s68 offen offset:0 nt
  v_add_f32_dpp v34, v30, v30 row_ror:8 row_mask:0xf bank_mask:0x3
  v_add_f32_dpp v34, v31, v31 row_ror:8 row_mask:0xf bank_mask:0xc
L_hop1800:
  s_cbranch_execz L_hop1819
  v_add_f32_dpp v35, v32, v32 row_ror:8 row_mask:0xf bank_mask:0x3
  v_add_f32_dpp v35, v33, v33 row_ror:8 row_mask:0xf bank_mask:0xc
  buffer_load_dwordx4 v[172:175], v1, s[44:47], s68 offen offset:1024 nt
  v_add_f32_dpp v36, v34, v34 row_ror:12 row_mask:0xf bank_mask:0x5
  v_add_f32_dpp v36, v35, v35 row_ror:4 row_mask:0xf bank_mask:0xa
  buffer_load_dwordx4 v[176:179], v1, s[44:47], s68 offen offset:2048 nt
  buffer_load_dwordx4 v[180:183], v1, s[44:47], s68 offen offset:3072 nt
  s_add_u32 s68, s68, 16384
  v_cvt_pk_bf16_f32 v37, v67, v67
  v_and_b32 v37, s80, v37
  v_mul_f32 v37, s79, v37
  v_cvt_pk_bf16_f32 v37, v37, v37
  v_and_b32 v67, s80, v37
  v_max_f32 v24, v24, v67
  v_add_f32_dpp v36, v36, v36 quad_perm:[2,3,0,1] row_mask:0xf bank_mask:0xf
  s_nop 1
  v_add_f32_dpp v68, v36, v36 quad_perm:[1,0,3,2] row_mask:0xf bank_mask:0xf
  s_waitcnt vmcnt(12)
L_hop1819:
  s_cbranch_execz L_hop1846
  v_dot2_f32_bf16 v30, v120, v8, 0
  v_dot2_f32_bf16 v31, v124, v8, 0
  v_dot2_f32_bf16 v32, v128, v8, 0
  v_dot2_f32_bf16 v33, v132, v8, 0
  v_dot2c_f32_bf16 v30, v121, v9
  v_dot2c_f32_bf16 v31, v125, v9
  v_dot2c_f32_bf16 v32, v129, v9
  v_dot2c_f32_bf16 v33, v133, v9
  v_dot2c_f32_bf16 v30, v122, v10
  v_dot2c_f32_bf16 v31, v126, v10
  v_dot2c_f32_bf16 v32, v130, v10
  v_dot2c_f32_bf16 v33, v134, v10
  v_dot2c_f32_bf16 v30, v123, v11
  v_dot2c_f32_bf16 v31, v127, v11
  v_dot2c_f32_bf16 v32, v131, v11
  v_dot2c_f32_bf16 v33, v135, v11
L_gl48:
  s_memrealtime s[30:31]
  s_waitcnt lgkmcnt(0)
  s_sub_u32 s29, s30, s28
  s_cmp_lt_u32 s29, 1592
  s_cbranch_scc0 L_gk47
  s_sleep 1
  s_branch L_gl48
L_gk47:
  buffer_load_dwordx4 v[200:203], v1, s[44:47], s68 offen offset:0 nt
L_hop1846:
  s_cbranch_execz L_hop1865
  v_add_f32_dpp v34, v30, v30 row_ror:8 row_mask:0xf bank_mask:0x3
  v_add_f32_dpp v34, v31, v31 row_ror:8 row_mask:0xf bank_mask:0xc
  v_add_f32_dpp v35, v32, v32 row_ror:8 row_mask:0xf bank_mask:0x3
  v_add_f32_dpp v35, v33, v33 row_ror:8 row_mask:0xf bank_mask:0xc
  buffer_load_dwordx4 v[204:207], v1, s[44:47], s68 offen offset:1024 nt
  v_add_f32_dpp v36, v34, v34 row_ror:12 row_mask:0xf bank_mask:0x5
  v_add_f32_dpp v36, v35, v35 row_ror:4 row_mask:0xf bank_mask:0xa
  buffer_load_dwordx4 v[208:211], v1, s[44:47], s68 offen offset:2048 nt
  buffer_load_dwordx4 v[212:215], v1, s[44:47], s68 offen offset:3072 nt
  s_add_u32 s68, s68, 16384
  v_cvt_pk_bf16_f32 v37, v68, v68
  v_and_b32 v37, s80, v37
  v_mul_f32 v37, s79, v37
  v_cvt_pk_bf16_f32 v37, v37, v37
  v_and_b32 v68, s80, v37
  v_max_f32 v24, v24, v68
  v_add_f32_dpp v36, v36, v36 quad_perm:[2,3,0,1] row_mask:0xf bank_mask:0xf
  s_nop 1
L_hop1865:
  s_cbranch_execz L_hop1893
  v_add_f32_dpp v69, v36, v36 quad_perm:[1,0,3,2] row_mask:0xf bank_mask:0xf
  s_waitcnt vmcnt(12)
  v_dot2_f32_bf16 v30, v136, v8, 0
  v_dot2_f32_bf16 v31, v140, v8, 0
  v_dot2_f32_bf16 v32, v144, v8, 0
  v_dot2_f32_bf16 v33, v148, v8, 0
  v_dot2c_f32_bf16 v30, v137, v9
  v_dot2c_f32_bf16 v31, v141, v9
  v_dot2c_f32_bf16 v32, v145, v9
  v_dot2c_f32_bf16 v33, v149, v9
  v_dot2c_f32_bf16 v30, v138, v10
  v_dot2c_f32_bf16 v31, v142, v10
  v_dot2c_f32_bf16 v32, v146, v10
  v_dot2c_f32_bf16 v33, v150, v10
  v_dot2c_f32_bf16 v30, v139, v11
  v_dot2c_f32_bf16 v31, v143, v11
  v_dot2c_f32_bf16 v32, v147, v11
  v_dot2c_f32_bf16 v33, v151, v11
L_gl50:
  s_memrealtime s[30:31]
  s_waitcnt lgkmcnt(0)
  s_sub_u32 s29, s30, s28
  s_cmp_lt_u32 s29, 1649
  s_cbranch_scc0 L_gk49
  s_sleep 1
  s_branch L_gl50
L_gk49:
L_hop1893:
  s_cbranch_execz L_hop1911
  buffer_load_dwordx4 v[228:231], v1, s[44:47], s68 offen offset:0 nt
  v_add_f32_dpp v34, v30, v30 row_ror:8 row_mask:0xf bank_mask:0x3
  v_add_f32_dpp v34, v31, v31 row_ror:8 row_mask:0xf bank_mask:0xc
  v_add_f32_dpp v35, v32, v32 row_ror:8 row_mask:0xf bank_mask:0x3
  v_add_f32_dpp v35, v33, v33 row_ror:8 row_mask:0xf bank_mask:0xc
  buffer_load_dwordx4 v[224:227], v1, s[44:47], s68 offen offset:1024 nt
  v_add_f32_dpp v36, v34, v34 row_ror:12 row_mask:0xf bank_mask:0x5
  v_add_f32_dpp v36, v35, v35 row_ror:4 row_mask:0xf bank_mask:0xa
  buffer_load_dwordx4 v[220:223], v1, s[44:47], s68 offen offset:2048 nt
  buffer_load_dwordx4 v[216:219], v1, s[44:47], s68 offen offset:3072 nt
  s_add_u32 s68, s68, 16384
  v_cvt_pk_bf16_f32 v37, v69, v69
  v_and_b32 v37, s80, v37
  v_mul_f32 v37, s79, v37
  v_cvt_pk_bf16_f32 v37, v37, v37
  v_and_b32 v69, s80, v37
  v_max_f32 v24, v24, v69
L_hop1911:
  s_cbranch_execz L_hop1941
  v_add_f32_dpp v36, v36, v36 quad_perm:[2,3,0,1] row_mask:0xf bank_mask:0xf
  s_nop 1
  v_add_f32_dpp v70, v36, v36 quad_perm:[1,0,3,2] row_mask:0xf bank_mask:0xf
  s_waitcnt vmcnt(12)
  v_dot2_f32_bf16 v30, v152, v8, 0
  v_dot2_f32_bf16 v31, v156, v8, 0
  v_dot2_f32_bf16 v32, v160, v8, 0
  v_dot2_f32_bf16 v33, v164, v8, 0
  v_dot2c_f32_bf16 v30, v153, v9
  v_dot2c_f32_bf16 v31, v157, v9
  v_dot2c_f32_bf16 v32, v161, v9
  v_dot2c_f32_bf16 v33, v165, v9
  v_dot2c_f32_bf16 v30, v154, v10
  v_dot2c_f32_bf16 v31, v158, v10
  v_dot2c_f32_bf16 v32, v162, v10
  v_dot2c_f32_bf16 v33, v166, v10
  v_dot2c_f32_bf16 v30, v155, v11
  v_dot2c_f32_bf16 v31, v159, v11
  v_dot2c_f32_bf16 v32, v163, v11
  v_dot2c_f32_bf16 v33, v167, v11
L_gl52:
  s_memrealtime s[30:31]
  s_waitcnt lgkmcnt(0)
  s_sub_u32 s29, s30, s28
  s_cmp_lt_u32 s29, 1706
  s_cbranch_scc0 L_gk51
  s_sleep 1
  s_branch L_gl52
L_gk51:
L_hop1941:
  s_cbranch_execz L_hop1957
  buffer_load_dwordx4 v[196:199], v1, s[44:47], s68 offen offset:0 nt
  v_add_f32_dpp v34, v30, v30 row_ror:8 row_mask:0xf bank_mask:0x3
  v_add_f32_dpp v34, v31, v31 row_ror:8 row_mask:0xf bank_mask:0xc
  v_add_f32_dpp v35, v32, v32 row_ror:8 row_mask:0xf bank_mask:0x3
  v_add_f32_dpp v35, v33, v33 row_ror:8 row_mask:0xf bank_mask:0xc
  buffer_load_dwordx4 v[192:195], v1, s[44:47], s68 offen offset:1024 nt
  v_add_f32_dpp v36, v34, v34 row_ror:12 row_mask:0xf bank_mask:0x5
  v_add_f32_dpp v36, v35, v35 row_ror:4 row_mask:0xf bank_mask:0xa
  buffer_load_dwordx4 v[188:191], v1, s[44:47], s68 offen offset:2048 nt
  buffer_load_dwordx4 v[184:187], v1, s[44:47], s68 offen offset:3072 nt
  s_add_u32 s68, s68, 16384
  v_cvt_pk_bf16_f32 v37, v70, v70
  v_and_b32 v37, s80, v37
  v_mul_f32 v37, s79, v37
  v_cvt_pk_bf16_f32 v37, v37, v37
L_hop1957:
  s_cbranch_execz L_hop1989
  v_and_b32 v70, s80, v37
  v_max_f32 v24, v24, v70
  v_add_f32_dpp v36, v36, v36 quad_perm:[2,3,0,1] row_mask:0xf bank_mask:0xf
  s_nop 1
  v_add_f32_dpp v71, v36, v36 quad_perm:[1,0,3,2] row_mask:0xf bank_mask:0xf
  s_waitcnt vmcnt(12)
  v_dot2_f32_bf16 v30, v168, v8, 0
  v_dot2_f32_bf16 v31, v172, v8, 0
  v_dot2_f32_bf16 v32, v176, v8, 0
  v_dot2_f32_bf16 v33, v180, v8, 0
  v_dot2c_f32_bf16 v30, v169, v9
  v_dot2c_f32_bf16 v31, v173, v9
  v_dot2c_f32_bf16 v32, v177, v9
  v_dot2c_f32_bf16 v33, v181, v9
  v_dot2c_f32_bf16 v30, v170, v10
  v_dot2c_f32_bf16 v31, v174, v10
  v_dot2c_f32_bf16 v32, v178, v10
  v_dot2c_f32_bf16 v33, v182, v10
  v_dot2c_f32_bf16 v30, v171, v11
  v_dot2c_f32_bf16 v31, v175, v11
  v_dot2c_f32_bf16 v32, v179, v11
  v_dot2c_f32_bf16 v33, v183, v11
L_gl54:
  s_memrealtime s[30:31]
  s_waitcnt lgkmcnt(0)
  s_sub_u32 s29, s30, s28
  s_cmp_lt_u32 s29, 1763
  s_cbranch_scc0 L_gk53
  s_sleep 1
  s_branch L_gl54
L_gk53:
L_hop1989:
  s_cbranch_execz L_hop2002
  buffer_load_dwordx4 v[232:235], v1, s[44:47], s68 offen offset:0 nt
  v_add_f32_dpp v34, v30, v30 row_ror:8 row_mask:0xf bank_mask:0x3
  v_add_f32_dpp v34, v31, v31 row_ror:8 row_mask:0xf bank_mask:0xc
  v_add_f32_dpp v35, v32, v32 row_ror:8 row_mask:0xf bank_mask:0x3
  v_add_f32_dpp v35, v33, v33 row_ror:8 row_mask:0xf bank_mask:0xc
  buffer_load_dwordx4 v[236:239], v1, s[44:47], s68 offen offset:1024 nt
  v_add_f32_dpp v36, v34, v34 row_ror:12 row_mask:0xf bank_mask:0x5
  v_add_f32_dpp v36, v35, v35 row_ror:4 row_mask:0xf bank_mask:0xa
  buffer_load_dwordx4 v[240:243], v1, s[44:47], s68 offen offset:2048 nt
  buffer_load_dwordx4 v[244:247], v1, s[44:47], s68 offen offset:3072 nt
  s_add_u32 s68, s68, 16384
  v_cvt_pk_bf16_f32 v37, v71, v71
L_hop2002:
  s_cbranch_execz L_hop2027
  v_and_b32 v37, s80, v37
  v_mul_f32 v37, s79, v37
  v_cvt_pk_bf16_f32 v37, v37, v37
  v_and_b32 v71, s80, v37
  v_max_f32 v24, v24, v71
  v_add_f32_dpp v36, v36, v36 quad_perm:[2,3,0,1] row_mask:0xf bank_mask:0xf
  s_nop 1
  v_add_f32_dpp v72, v36, v36 quad_perm:[1,0,3,2] row_mask:0xf bank_mask:0xf
  s_waitcnt vmcnt(12)
  v_dot2_f32_bf16 v30, v200, v8, 0
  v_dot2_f32_bf16 v31, v204, v8, 0
  v_dot2_f32_bf16 v32, v208, v8, 0
  v_dot2_f32_bf16 v33, v212, v8, 0
  v_dot2c_f32_bf16 v30, v201, v9
  v_dot2c_f32_bf16 v31, v205, v9
  v_dot2c_f32_bf16 v32, v209, v9
  v_dot2c_f32_bf16 v33, v213, v9
  v_dot2c_f32_bf16 v30, v202, v10
  v_dot2c_f32_bf16 v31, v206, v10
  v_dot2c_f32_bf16 v32, v210, v10
  v_dot2c_f32_bf16 v33, v214, v10
  v_dot2c_f32_bf16 v30, v203, v11
  v_dot2c_f32_bf16 v31, v207, v11
  v_dot2c_f32_bf16 v32, v211, v11
L_hop2027:
  s_cbranch_execz L_hop2049
  v_dot2c_f32_bf16 v33, v215, v11
L_gl56:
  s_memrealtime s[30:31]
  s_waitcnt lgkmcnt(0)
  s_sub_u32 s29, s30, s28
  s_cmp_lt_u32 s29, 1820
  s_cbranch_scc0 L_gk55
  s_sleep 1
  s_branch L_gl56
L_gk55:
  buffer_load_dwordx4 v[248:251], v1, s[44:47], s68 offen offset:0 nt
  v_add_f32_dpp v34, v30, v30 row_ror:8 row_mask:0xf bank_mask:0x3
  v_add_f32_dpp v34, v31, v31 row_ror:8 row_mask:0xf bank_mask:0xc
  v_add_f32_dpp v35, v32, v32 row_ror:8 row_mask:0xf bank_mask:0x3
  v_add_f32_dpp v35, v33, v33 row_ror:8 row_mask:0xf bank_mask:0xc
  buffer_load_dwordx4 v[252:255], v1, s[44:47], s68 offen offset:1024 nt
  v_add_f32_dpp v36, v34, v34 row_ror:12 row_mask:0xf bank_mask:0x5
  v_add_f32_dpp v36, v35, v35 row_ror:4 row_mask:0xf bank_mask:0xa
  buffer_load_dwordx4 v[80:83], v1, s[44:47], s68 offen offset:2048 nt
  buffer_load_dwordx4 v[84:87], v1, s[44:47], s68 offen offset:3072 nt
  s_add_u32 s68, s68, 16384
L_hop2049:
  s_cbranch_execz L_hop2072
  v_cvt_pk_bf16_f32 v37, v72, v72
  v_and_b32 v37, s80, v37
  v_mul_f32 v37, s79, v37
  v_cvt_pk_bf16_f32 v37, v37, v37
  v_and_b32 v72, s80, v37
  v_max_f32 v24, v24, v72
  v_add_f32_dpp v36, v36, v36 quad_perm:[2,3,0,1] row_mask:0xf bank_mask:0xf
  s_nop 1
  v_add_f32_dpp v73, v36, v36 quad_perm:[1,0,3,2] row_mask:0xf bank_mask:0xf
  s_waitcnt vmcnt(12)
  v_dot2_f32_bf16 v30, v228, v8, 0
  v_dot2_f32_bf16 v31, v224, v8, 0
  v_dot2_f32_bf16 v32, v220, v8, 0
  v_dot2_f32_bf16 v33, v216, v8, 0
  v_dot2c_f32_bf16 v30, v229, v9
  v_dot2c_f32_bf16 v31, v225, v9
  v_dot2c_f32_bf16 v32, v221, v9
  v_dot2c_f32_bf16 v33, v217, v9
  v_dot2c_f32_bf16 v30, v230, v10
  v_dot2c_f32_bf16 v31, v226, v10
  v_dot2c_f32_bf16 v32, v222, v10
  v_dot2c_f32_bf16 v33, v218, v10
L_hop2072:
  s_cbranch_execz L_hop2095
  v_dot2c_f32_bf16 v30, v231, v11
  v_dot2c_f32_bf16 v31, v227, v11
  v_dot2c_f32_bf16 v32, v223, v11
  v_dot2c_f32_bf16 v33, v219, v11
L_gl58:
  s_memrealtime s[30:31]
  s_waitcnt lgkmcnt(0)
  s_sub_u32 s29, s30, s28
  s_cmp_lt_u32 s29, 1877
  s_cbranch_scc0 L_gk57
  s_sleep 1
  s_branch L_gl58
L_gk57:
  buffer_load_dwordx4 v[88:91], v1, s[44:47], s68 offen offset:0 nt
  v_add_f32_dpp v34, v30, v30 row_ror:8 row_mask:0xf bank_mask:0x3
  v_add_f32_dpp v34, v31, v31 row_ror:8 row_mask:0xf bank_mask:0xc
  v_add_f32_dpp v35, v32, v32 row_ror:8 row_mask:0xf bank_mask:0x3
  v_add_f32_dpp v35, v33, v33 row_ror:8 row_mask:0xf bank_mask:0xc
  buffer_load_dwordx4 v[92:95], v1, s[44:47], s68 offen offset:1024 nt
  v_add_f32_dpp v36, v34, v34 row_ror:12 row_mask:0xf bank_mask:0x5
  v_add_f32_dpp v36, v35, v35 row_ror:4 row_mask:0xf bank_mask:0xa
  buffer_load_dwordx4 v[96:99], v1, s[44:47], s68 offen offset:2048 nt
L_hop2095:
  s_cbranch_execz L_hop2117
  buffer_load_dwordx4 v[100:103], v1, s[44:47], s68 offen offset:3072 nt
  s_add_u32 s68, s68, 16384
  v_cvt_pk_bf16_f32 v37, v73, v73
  v_and_b32 v37, s80, v37
  v_mul_f32 v37, s79, v37
  v_cvt_pk_bf16_f32 v37, v37, v37
  v_and_b32 v73, s80, v37
  v_max_f32 v24, v24, v73
  v_add_f32_dpp v36, v36, v36 quad_perm:[2,3,0,1] row_mask:0xf bank_mask:0xf
  s_nop 1
  v_add_f32_dpp v74, v36, v36 quad_perm:[1,0,3,2] row_mask:0xf bank_mask:0xf
  s_waitcnt vmcnt(12)
  v_dot2_f32_bf16 v30, v196, v8, 0
  v_dot2_f32_bf16 v31, v192, v8, 0
  v_dot2_f32_bf16 v32, v188, v8, 0
  v_dot2_f32_bf16 v33, v184, v8, 0
  v_dot2c_f32_bf16 v30, v197, v9
  v_dot2c_f32_bf16 v31, v193, v9
  v_dot2c_f32_bf16 v32, v189, v9
  v_dot2c_f32_bf16 v33, v185, v9
  v_dot2c_f32_bf16 v30, v198, v10
L_hop2117:
  s_cbranch_execz L_hop2142
  v_dot2c_f32_bf16 v31, v194, v10
  v_dot2c_f32_bf16 v32, v190, v10
  v_dot2c_f32_bf16 v33, v186, v10
  v_dot2c_f32_bf16 v30, v199, v11
  v_dot2c_f32_bf16 v31, v195, v11
  v_dot2c_f32_bf16 v32, v191, v11
  v_dot2c_f32_bf16 v33, v187, v11
L_gl60:
  s_memrealtime s[30:31]
  s_waitcnt lgkmcnt(0)
  s_sub_u32 s29, s30, s28
  s_cmp_lt_u32 s29, 1934
  s_cbranch_scc0 L_gk59
  s_sleep 1
  s_branch L_gl60
L_gk59:
  buffer_load_dwordx4 v[104:107], v1, s[44:47], s68 offen offset:0 nt
  v_add_f32_dpp v34, v30, v30 row_ror:8 row_mask:0xf bank_mask:0x3
  v_add_f32_dpp v34, v31, v31 row_ror:8 row_mask:0xf bank_mask:0xc
  v_add_f32_dpp v35, v32, v32 row_ror:8 row_mask:0xf bank_mask:0x3
  v_add_f32_dpp v35, v33, v33 row_ror:8 row_mask:0xf bank_mask:0xc
  buffer_load_dwordx4 v[108:111], v1, s[44:47], s68 offen offset:1024 nt
  v_add_f32_dpp v36, v34, v34 row_ror:12 row_mask:0xf bank_mask:0x5
  v_add_f32_dpp v36, v35, v35 row_ror:4 row_mask:0xf bank_mask:0xa
L_hop2142:
  s_cbranch_execz L_hop2163
  buffer_load_dwordx4 v[112:115], v1, s[44:47], s68 offen offset:2048 nt
  buffer_load_dwordx4 v[116:119], v1, s[44:47], s68 offen offset:3072 nt
  v_cvt_pk_bf16_f32 v37, v74, v74
  v_and_b32 v37, s80, v37
  v_mul_f32 v37, s79, v37
  v_cvt_pk_bf16_f32 v37, v37, v37
  v_and_b32 v74, s80, v37
  v_max_f32 v24, v24, v74
  v_add_f32_dpp v36, v36, v36 quad_perm:[2,3,0,1] row_mask:0xf bank_mask:0xf
  s_nop 1
  v_add_f32_dpp v75, v36, v36 quad_perm:[1,0,3,2] row_mask:0xf bank_mask:0xf
  s_waitcnt vmcnt(12)
  v_dot2_f32_bf16 v30, v232, v8, 0
  v_dot2_f32_bf16 v31, v236, v8, 0
  v_dot2_f32_bf16 v32, v240, v8, 0
  v_dot2_f32_bf16 v33, v244, v8, 0
  v_dot2c_f32_bf16 v30, v233, v9
  v_dot2c_f32_bf16 v31, v237, v9
  v_dot2c_f32_bf16 v32, v241, v9
  v_dot2c_f32_bf16 v33, v245, v9
L_hop2163:
  s_cbranch_execz L_hop2188
  v_dot2c_f32_bf16 v30, v234, v10
  v_dot2c_f32_bf16 v31, v238, v10
  v_dot2c_f32_bf16 v32, v242, v10
  v_dot2c_f32_bf16 v33, v246, v10
  v_dot2c_f32_bf16 v30, v235, v11
  v_dot2c_f32_bf16 v31, v239, v11
  v_dot2c_f32_bf16 v32, v243, v11
  v_dot2c_f32_bf16 v33, v247, v11
L_gl62:
  s_memrealtime s[30:31]
  s_waitcnt lgkmcnt(0)
  s_sub_u32 s29, s30, s28
  s_cmp_lt_u32 s29, 1991
  s_cbranch_scc0 L_gk61
  s_sleep 1
  s_branch L_gl62
L_gk61:
  buffer_load_dwordx4 v[120:123], v1, s[48:51], s69 offen offset:0 nt
  v_add_f32_dpp v34, v30, v30 row_ror:8 row_mask:0xf bank_mask:0x3
  v_add_f32_dpp v34, v31, v31 row_ror:8 row_mask:0xf bank_mask:0xc
  v_add_f32_dpp v35, v32, v32 row_ror:8 row_mask:0xf bank_mask:0x3
  v_add_f32_dpp v35, v33, v33 row_ror:8 row_mask:0xf bank_mask:0xc
  buffer_load_dwordx4 v[124:127], v1, s[48:51], s69 offen offset:1024 nt
  v_add_f32_dpp v36, v34, v34 row_ror:12 row_mask:0xf bank_mask:0x5
L_hop2188:
  s_cbranch_execz L_hop2208
  v_add_f32_dpp v36, v35, v35 row_ror:4 row_mask:0xf bank_mask:0xa
  buffer_load_dwordx4 v[128:131], v1, s[48:51], s69 offen offset:2048 nt
  buffer_load_dwordx4 v[132:135], v1, s[48:51], s69 offen offset:3072 nt
  s_add_u32 s69, s69, 16384
  v_cvt_pk_bf16_f32 v37, v75, v75
  v_and_b32 v37, s80, v37
  v_mul_f32 v37, s79, v37
  v_cvt_pk_bf16_f32 v37, v37, v37
  v_and_b32 v75, s80, v37
  v_max_f32 v24, v24, v75
  v_add_f32_dpp v36, v36, v36 quad_perm:[2,3,0,1] row_mask:0xf bank_mask:0xf
  s_nop 1
  v_add_f32_dpp v76, v36, v36 quad_perm:[1,0,3,2] row_mask:0xf bank_mask:0xf
  s_waitcnt vmcnt(12)
  v_dot2_f32_bf16 v30, v248, v8, 0
  v_dot2_f32_bf16 v31, v252, v8, 0
  v_dot2_f32_bf16 v32, v80, v8, 0
  v_dot2_f32_bf16 v33, v84, v8, 0
  v_dot2c_f32_bf16 v30, v249, v9
L_hop2208:
  s_cbranch_execz L_hop2235
  v_dot2c_f32_bf16 v31, v253, v9
  v_dot2c_f32_bf16 v32, v81, v9
  v_dot2c_f32_bf16 v33, v85, v9
  v_dot2c_f32_bf16 v30, v250, v10
  v_dot2c_f32_bf16 v31, v254, v10
  v_dot2c_f32_bf16 v32, v82, v10
  v_dot2c_f32_bf16 v33, v86, v10
  v_dot2c_f32_bf16 v30, v251, v11
  v_dot2c_f32_bf16 v31, v255, v11
  v_dot2c_f32_bf16 v32, v83, v11
  v_dot2c_f32_bf16 v33, v87, v11
L_gl64:
  s_memrealtime s[30:31]
  s_waitcnt lgkmcnt(0)
  s_sub_u32 s29, s30, s28
  s_cmp_lt_u32 s29, 2048
  s_cbranch_scc0 L_gk63
  s_sleep 1
  s_branch L_gl64
L_gk63:
  buffer_load_dwordx4 v[136:139], v1, s[48:51], s69 offen offset:0 nt
  v_add_f32_dpp v34, v30, v30 row_ror:8 row_mask:0xf bank_mask:0x3
  v_add_f32_dpp v34, v31, v31 row_ror:8 row_mask:0xf bank_mask:0xc
  v_add_f32_dpp v35, v32, v32 row_ror:8 row_mask:0xf bank_mask:0x3
  v_add_f32_dpp v35, v33, v33 row_ror:8 row_mask:0xf bank_mask:0xc
  buffer_load_dwordx4 v[140:143], v1, s[48:51], s69 offen offset:1024 nt
L_hop2235:
  s_cbranch_execz L_hop2254
  v_add_f32_dpp v36, v34, v34 row_ror:12 row_mask:0xf bank_mask:0x5
  v_add_f32_dpp v36, v35, v35 row_ror:4 row_mask:0xf bank_mask:0xa
  buffer_load_dwordx4 v[144:147], v1, s[48:51], s69 offen offset:2048 nt
  buffer_load_dwordx4 v[148:151], v1, s[48:51], s69 offen offset:3072 nt
  s_add_u32 s69, s69, 16384
  v_cvt_pk_bf16_f32 v37, v76, v76
  v_and_b32 v37, s80, v37
  v_mul_f32 v37, s79, v37
  v_cvt_pk_bf16_f32 v37, v37, v37
  v_and_b32 v76, s80, v37
  v_max_f32 v24, v24, v76
  v_add_f32_dpp v36, v36, v36 quad_perm:[2,3,0,1] row_mask:0xf bank_mask:0xf
  s_nop 1
  v_add_f32_dpp v77, v36, v36 quad_perm:[1,0,3,2] row_mask:0xf bank_mask:0xf
  s_waitcnt vmcnt(12)
  v_dot2_f32_bf16 v30, v88, v8, 0
  v_dot2_f32_bf16 v31, v92, v8, 0
  v_dot2_f32_bf16 v32, v96, v8, 0
L_hop2254:
  s_cbranch_execz L_hop2281
  v_dot2_f32_bf16 v33, v100, v8, 0
  v_dot2c_f32_bf16 v30, v89, v9
  v_dot2c_f32_bf16 v31, v93, v9
  v_dot2c_f32_bf16 v32, v97, v9
  v_dot2c_f32_bf16 v33, v101, v9
  v_dot2c_f32_bf16 v30, v90, v10
  v_dot2c_f32_bf16 v31, v94, v10
  v_dot2c_f32_bf16 v32, v98, v10
  v_dot2c_f32_bf16 v33, v102, v10
  v_dot2c_f32_bf16 v30, v91, v11
  v_dot2c_f32_bf16 v31, v95, v11
  v_dot2c_f32_bf16 v32, v99, v11
  v_dot2c_f32_bf16 v33, v103, v11
L_gl66:
  s_memrealtime s[30:31]
  s_waitcnt lgkmcnt(0)
  s_sub_u32 s29, s30, s28
  s_cmp_lt_u32 s29, 2105
  s_cbranch_scc0 L_gk65
  s_sleep 1
  s_branch L_gl66
L_gk65:
  buffer_load_dwordx4 v[152:155], v1, s[48:51], s69 offen offset:0 nt
  v_add_f32_dpp v34, v30, v30 row_ror:8 row_mask:0xf bank_mask:0x3
  v_add_f32_dpp v34, v31, v31 row_ror:8 row_mask:0xf bank_mask:0xc
  v_add_f32_dpp v35, v32, v32 row_ror:8 row_mask:0xf bank_mask:0x3
L_hop2281:
  s_cbranch_execz L_hop2301
  v_add_f32_dpp v35, v33, v33 row_ror:8 row_mask:0xf bank_mask:0xc
  buffer_load_dwordx4 v[156:159], v1, s[48:51], s69 offen offset:1024 nt
  v_add_f32_dpp v36, v34, v34 row_ror:12 row_mask:0xf bank_mask:0x5
  v_add_f32_dpp v36, v35, v35 row_ror:4 row_mask:0xf bank_mask:0xa
  buffer_load_dwordx4 v[160:163], v1, s[48:51], s69 offen offset:2048 nt
  buffer_load_dwordx4 v[164:167], v1, s[48:51], s69 offen offset:3072 nt
  s_add_u32 s69, s69, 16384
  v_cvt_pk_bf16_f32 v37, v77, v77
  v_and_b32 v37, s80, v37
  v_mul_f32 v37, s79, v37
  v_cvt_pk_bf16_f32 v37, v37, v37
  v_and_b32 v77, s80, v37
  v_max_f32 v24, v24, v77
  v_add_f32_dpp v36, v36, v36 quad_perm:[2,3,0,1] row_mask:0xf bank_mask:0xf
  s_nop 1
  v_add_f32_dpp v78, v36, v36 quad_perm:[1,0,3,2] row_mask:0xf bank_mask:0xf
  s_waitcnt vmcnt(12)
  v_dot2_f32_bf16 v30, v104, v8, 0
  v_dot2_f32_bf16 v31, v108, v8, 0
L_hop2301:
  s_cbranch_execz L_hop2328
  v_dot2_f32_bf16 v32, v112, v8, 0
  v_dot2_f32_bf16 v33, v116, v8, 0
  v_dot2c_f32_bf16 v30, v105, v9
  v_dot2c_f32_bf16 v31, v109, v9
  v_dot2c_f32_bf16 v32, v113, v9
  v_dot2c_f32_bf16 v33, v117, v9
  v_dot2c_f32_bf16 v30, v106, v10
  v_dot2c_f32_bf16 v31, v110, v10
  v_dot2c_f32_bf16 v32, v114, v10
  v_dot2c_f32_bf16 v33, v118, v10
  v_dot2c_f32_bf16 v30, v107, v11
  v_dot2c_f32_bf16 v31, v111, v11
  v_dot2c_f32_bf16 v32, v115, v11
  v_dot2c_f32_bf16 v33, v119, v11
L_gl68:
  s_memrealtime s[30:31]
  s_waitcnt lgkmcnt(0)
  s_sub_u32 s29, s30, s28
  s_cmp_lt_u32 s29, 2162
  s_cbranch_scc0 L_gk67
  s_sleep 1
  s_branch L_gl68
L_gk67:
  buffer_load_dwordx4 v[168:171], v1, s[48:51], s69 offen offset:0 nt
  v_add_f32_dpp v34, v30, v30 row_ror:8 row_mask:0xf bank_mask:0x3
  v_add_f32_dpp v34, v31, v31 row_ror:8 row_mask:0xf bank_mask:0xc
L_hop2328:
  s_cbranch_execz L_hop2347
  v_add_f32_dpp v35, v32, v32 row_ror:8 row_mask:0xf bank_mask:0x3
  v_add_f32_dpp v35, v33, v33 row_ror:8 row_mask:0xf bank_mask:0xc
  buffer_load_dwordx4 v[172:175], v1, s[48:51], s69 offen offset:1024 nt
  v_add_f32_dpp v36, v34, v34 row_ror:12 row_mask:0xf bank_mask:0x5
  v_add_f32_dpp v36, v35, v35 row_ror:4 row_mask:0xf bank_mask:0xa
  buffer_load_dwordx4 v[176:179], v1, s[48:51], s69 offen offset:2048 nt
  buffer_load_dwordx4 v[180:183], v1, s[48:51], s69 offen offset:3072 nt
  s_add_u32 s69, s69, 16384
  v_cvt_pk_bf16_f32 v37, v78, v78
  v_and_b32 v37, s80, v37
  v_mul_f32 v37, s79, v37
  v_cvt_pk_bf16_f32 v37, v37, v37
  v_and_b32 v78, s80, v37
  v_max_f32 v24, v24, v78
  v_add_f32_dpp v36, v36, v36 quad_perm:[2,3,0,1] row_mask:0xf bank_mask:0xf
  s_nop 1
  v_add_f32_dpp v79, v36, v36 quad_perm:[1,0,3,2] row_mask:0xf bank_mask:0xf
  v_cvt_pk_bf16_f32 v37, v79, v79
L_hop2347:
  s_cbranch_execz L_hop2373
  v_and_b32 v37, s80, v37
  v_mul_f32 v37, s79, v37
  v_cvt_pk_bf16_f32 v37, v37, v37
  v_and_b32 v79, s80, v37
  v_max_f32 v24, v24, v79
  s_nop 1
  v_max_f32_dpp v24, v24, v24 row_ror:4 row_mask:0xf bank_mask:0xf
  s_nop 1
  v_max_f32_dpp v24, v24, v24 row_ror:8 row_mask:0xf bank_mask:0xf
  v_mov_b32 v41, v24
  s_nop 1
  v_permlane16_swap_b32 v24, v41
  v_max_f32 v24, v24, v41
  v_mov_b32 v41, v24
  s_nop 1
  v_permlane32_swap_b32 v24, v41
  v_max_f32 v24, v24, v41
  v_mul_f32 v26, s78, v24
  v_sub_f32 v26, 0, v26
  v_mov_b32 v32, 0
  v_fma_f32 v30, v48, s78, v26
  v_fma_f32 v31, v49, s78, v26
  v_exp_f32 v30, v30
  v_exp_f32 v31, v31
  v_cvt_pk_bf16_f32 v48, v30, v30
L_hop2373:
  s_cbranch_execz L_hop2394
  v_cvt_pk_bf16_f32 v49, v31, v31
  v_add_f32 v25, v25, v30
  v_add_f32 v32, v32, v31
  v_fma_f32 v30, v50, s78, v26
  v_fma_f32 v31, v51, s78, v26
  v_exp_f32 v30, v30
  v_exp_f32 v31, v31
  v_cvt_pk_bf16_f32 v50, v30, v30
  v_cvt_pk_bf16_f32 v51, v31, v31
  v_add_f32 v25, v25, v30
  v_add_f32 v32, v32, v31
  v_fma_f32 v30, v52, s78, v26
  v_fma_f32 v31, v53, s78, v26
  v_exp_f32 v30, v30
  v_exp_f32 v31, v31
  v_cvt_pk_bf16_f32 v52, v30, v30
  v_cvt_pk_bf16_f32 v53, v31, v31
  v_add_f32 v25, v25, v30
  v_add_f32 v32, v32, v31
  v_fma_f32 v30, v54, s78, v26
L_hop2394:
  s_cbranch_execz L_hop2419
  v_fma_f32 v31, v55, s78, v26
  v_exp_f32 v30, v30
  v_exp_f32 v31, v31
  v_cvt_pk_bf16_f32 v54, v30, v30
  v_cvt_pk_bf16_f32 v55, v31, v31
  v_add_f32 v25, v25, v30
  v_add_f32 v32, v32, v31
  s_waitcnt vmcnt(15)
L_gl70:
  s_memrealtime s[30:31]
  s_waitcnt lgkmcnt(0)
  s_sub_u32 s29, s30, s28
  s_cmp_lt_u32 s29, 2219
  s_cbranch_scc0 L_gk69
  s_sleep 1
  s_branch L_gl70
L_gk69:
  buffer_load_dwordx4 v[200:203], v1, s[48:51], s69 offen offset:0 nt
  v_fma_f32 v30, v56, s78, v26
  v_fma_f32 v31, v57, s78, v26
  v_exp_f32 v30, v30
  v_exp_f32 v31, v31
  v_cvt_pk_bf16_f32 v56, v30, v30
  v_cvt_pk_bf16_f32 v57, v31, v31
L_hop2419:
  s_cbranch_execz L_hop2440
  v_add_f32 v25, v25, v30
  v_add_f32 v32, v32, v31
  v_fma_f32 v30, v58, s78, v26
  v_fma_f32 v31, v59, s78, v26
  v_exp_f32 v30, v30
  v_exp_f32 v31, v31
  v_cvt_pk_bf16_f32 v58, v30, v30
  v_cvt_pk_bf16_f32 v59, v31, v31
  v_add_f32 v25, v25, v30
  v_add_f32 v32, v32, v31
  v_fma_f32 v30, v60, s78, v26
  v_fma_f32 v31, v61, s78, v26
  v_exp_f32 v30, v30
  v_exp_f32 v31, v31
  v_cvt_pk_bf16_f32 v60, v30, v30
  v_cvt_pk_bf16_f32 v61, v31, v31
  v_add_f32 v25, v25, v30
  v_add_f32 v32, v32, v31
  v_fma_f32 v30, v62, s78, v26
  v_fma_f32 v31, v63, s78, v26
L_hop2440:
  s_cbranch_execz L_hop2462
  v_exp_f32 v30, v30
  v_exp_f32 v31, v31
  v_cvt_pk_bf16_f32 v62, v30, v30
  v_cvt_pk_bf16_f32 v63, v31, v31
  v_add_f32 v25, v25, v30
  v_add_f32 v32, v32, v31
  s_waitcnt vmcnt(15)
  buffer_load_dwordx4 v[204:207], v1, s[48:51], s69 offen offset:1024 nt
  v_fma_f32 v30, v64, s78, v26
  v_fma_f32 v31, v65, s78, v26
  v_exp_f32 v30, v30
  v_exp_f32 v31, v31
  v_cvt_pk_bf16_f32 v64, v30, v30
  v_cvt_pk_bf16_f32 v65, v31, v31
  v_add_f32 v25, v25, v30
  v_add_f32 v32, v32, v31
  v_fma_f32 v30, v66, s78, v26
  v_fma_f32 v31, v67, s78, v26
  v_exp_f32 v30, v30
  v_exp_f32 v31, v31
  v_cvt_pk_bf16_f32 v66, v30, v30
L_hop2462:
  s_cbranch_execz L_hop2484
  v_cvt_pk_bf16_f32 v67, v31, v31
  v_add_f32 v25, v25, v30
  v_add_f32 v32, v32, v31
  v_fma_f32 v30, v68, s78, v26
  v_fma_f32 v31, v69, s78, v26
  v_exp_f32 v30, v30
  v_exp_f32 v31, v31
  v_cvt_pk_bf16_f32 v68, v30, v30
  v_cvt_pk_bf16_f32 v69, v31, v31
  v_add_f32 v25, v25, v30
  v_add_f32 v32, v32, v31
  v_fma_f32 v30, v70, s78, v26
  v_fma_f32 v31, v71, s78, v26
  v_exp_f32 v30, v30
  v_exp_f32 v31, v31
  v_cvt_pk_bf16_f32 v70, v30, v30
  v_cvt_pk_bf16_f32 v71, v31, v31
  v_add_f32 v25, v25, v30
  v_add_f32 v32, v32, v31
  s_waitcnt vmcnt(15)
  buffer_load_dwordx4 v[208:211], v1, s[48:51], s69 offen offset:2048 nt
L_hop2484:
  s_cbranch_execz L_hop2506
  v_fma_f32 v30, v72, s78, v26
  v_fma_f32 v31, v73, s78, v26
  v_exp_f32 v30, v30
  v_exp_f32 v31, v31
  v_cvt_pk_bf16_f32 v72, v30, v30
  v_cvt_pk_bf16_f32 v73, v31, v31
  v_add_f32 v25, v25, v30
  v_add_f32 v32, v32, v31
  v_fma_f32 v30, v74, s78, v26
  v_fma_f32 v31, v75, s78, v26
  v_exp_f32 v30, v30
  v_exp_f32 v31, v31
  v_cvt_pk_bf16_f32 v74, v30, v30
  v_cvt_pk_bf16_f32 v75, v31, v31
  v_add_f32 v25, v25, v30
  v_add_f32 v32, v32, v31
  v_fma_f32 v30, v76, s78, v26
  v_fma_f32 v31, v77, s78, v26
  v_exp_f32 v30, v30
  v_exp_f32 v31, v31
  v_cvt_pk_bf16_f32 v76, v30, v30
L_hop2506:
  s_cbranch_execz L_hop2528
  v_cvt_pk_bf16_f32 v77, v31, v31
  v_add_f32 v25, v25, v30
  v_add_f32 v32, v32, v31
  v_fma_f32 v30, v78, s78, v26
  v_fma_f32 v31, v79, s78, v26
  v_exp_f32 v30, v30
  v_exp_f32 v31, v31
  v_cvt_pk_bf16_f32 v78, v30, v30
  v_cvt_pk_bf16_f32 v79, v31, v31
  v_add_f32 v25, v25, v30
  v_add_f32 v32, v32, v31
  s_waitcnt vmcnt(15)
  buffer_load_dwordx4 v[212:215], v1, s[48:51], s69 offen offset:3072 nt
  s_add_u32 s69, s69, 16384
  v_add_f32 v25, v25, v32
  s_nop 1
  v_add_f32_dpp v25, v25, v25 row_ror:4 row_mask:0xf bank_mask:0xf
  s_nop 1
  v_add_f32_dpp v25, v25, v25 row_ror:8 row_mask:0xf bank_mask:0xf
  v_mov_b32 v41, v25
  s_nop 1
L_hop2528:
  s_cbranch_execz L_hop2551
  v_permlane16_swap_b32 v25, v41
  v_add_f32 v25, v25, v41
  v_mov_b32 v41, v25
  s_nop 1
  v_permlane32_swap_b32 v25, v41
  v_add_f32 v25, v25, v41
  s_lshl_b32 s77, s3, 3
  v_mov_b32 v44, s77
  v_mov_b32 v41, 0
  v_mov_b32 v45, 1
  s_mov_b64 exec, 1
  ds_write_b64 v44, v[24:25] offset:64
  ds_add_u32 v41, v45 offset:12
  s_mov_b64 exec, -1
  v_and_b32_dpp v12, v48, v4 row_newbcast:0 row_mask:0xf bank_mask:0xf
  v_and_b32_dpp v13, v48, v5 row_newbcast:0 row_mask:0xf bank_mask:0xf
  v_and_b32_dpp v14, v48, v6 row_newbcast:0 row_mask:0xf bank_mask:0xf
  v_and_b32_dpp v15, v48, v7 row_newbcast:0 row_mask:0xf bank_mask:0xf
  v_and_b32_dpp v16, v48, v4 row_newbcast:8 row_mask:0xf bank_mask:0xf
  v_and_b32_dpp v17, v48, v5 row_newbcast:8 row_mask:0xf bank_mask:0xf
  v_and_b32_dpp v18, v48, v6 row_newbcast:8 row_mask:0xf bank_mask:0xf
  v_and_b32_dpp v19, v48, v7 row_newbcast:8 row_mask:0xf bank_mask:0xf
L_hop2551:
  s_cbranch_execz L_hop2568
  v_mfma_f32_16x16x32_bf16 v[20:23], v[12:15], v[120:123], 0
  v_and_b32_dpp v12, v48, v4 row_newbcast:4 row_mask:0xf bank_mask:0xf
  v_and_b32_dpp v13, v48, v5 row_newbcast:4 row_mask:0xf bank_mask:0xf
  v_and_b32_dpp v14, v48, v6 row_newbcast:4 row_mask:0xf bank_mask:0xf
  v_and_b32_dpp v15, v48, v7 row_newbcast:4 row_mask:0xf bank_mask:0xf
  v_mfma_f32_16x16x32_bf16 v[20:23], v[16:19], v[124:127], v[20:23]
  v_and_b32_dpp v16, v48, v4 row_newbcast:12 row_mask:0xf bank_mask:0xf
  v_and_b32_dpp v17, v48, v5 row_newbcast:12 row_mask:0xf bank_mask:0xf
  v_and_b32_dpp v18, v48, v6 row_newbcast:12 row_mask:0xf bank_mask:0xf
  v_and_b32_dpp v19, v48, v7 row_newbcast:12 row_mask:0xf bank_mask:0xf
  v_mfma_f32_16x16x32_bf16 v[20:23], v[12:15], v[128:131], v[20:23]
  s_nop 0
  v_mfma_f32_16x16x32_bf16 v[20:23], v[16:19], v[132:135], v[20:23]
  s_waitcnt vmcnt(12)
  v_and_b32_dpp v12, v49, v4 row_newbcast:0 row_mask:0xf bank_mask:0xf
  v_and_b32_dpp v13, v49, v5 row_newbcast:0 row_mask:0xf bank_mask:0xf
L_hop2568:
  s_cbranch_execz L_hop2585
  v_and_b32_dpp v14, v49, v6 row_newbcast:0 row_mask:0xf bank_mask:0xf
  v_and_b32_dpp v15, v49, v7 row_newbcast:0 row_mask:0xf bank_mask:0xf
  v_and_b32_dpp v16, v49, v4 row_newbcast:8 row_mask:0xf bank_mask:0xf
  v_and_b32_dpp v17, v49, v5 row_newbcast:8 row_mask:0xf bank_mask:0xf
  v_and_b32_dpp v18, v49, v6 row_newbcast:8 row_mask:0xf bank_mask:0xf
  v_and_b32_dpp v19, v49, v7 row_newbcast:8 row_mask:0xf bank_mask:0xf
  v_mfma_f32_16x16x32_bf16 v[20:23], v[12:15], v[136:139], v[20:23]
  v_and_b32_dpp v12, v49, v4 row_newbcast:4 row_mask:0xf bank_mask:0xf
  v_and_b32_dpp v13, v49, v5 row_newbcast:4 row_mask:0xf bank_mask:0xf
  v_and_b32_dpp v14, v49, v6 row_newbcast:4 row_mask:0xf bank_mask:0xf
  v_and_b32_dpp v15, v49, v7 row_newbcast:4 row_mask:0xf bank_mask:0xf
  v_mfma_f32_16x16x32_bf16 v[20:23], v[16:19], v[140:143], v[20:23]
  v_and_b32_dpp v16, v49, v4 row_newbcast:12 row_mask:0xf bank_mask:0xf
  v_and_b32_dpp v17, v49, v5 row_newbcast:12 row_mask:0xf bank_mask:0xf
  v_and_b32_dpp v18, v49, v6 row_newbcast:12 row_mask:0xf bank_mask:0xf
  v_and_b32_dpp v19, v49, v7 row_newbcast:12 row_mask:0xf bank_mask:0xf
L_hop2585:
  s_cbranch_execz L_hop2606
  v_mfma_f32_16x16x32_bf16 v[20:23], v[12:15], v[144:147], v[20:23]
L_gl72:
  s_memrealtime s[30:31]
  s_waitcnt lgkmcnt(0)
  s_sub_u32 s29, s30, s28
  s_cmp_lt_u32 s29, 2283
  s_cbranch_scc0 L_gk71
  s_sleep 1
  s_branch L_gl72
L_gk71:
  buffer_load_dwordx4 v[228:231], v1, s[48:51], s69 offen offset:0 nt
  buffer_load_dwordx4 v[224:227], v1, s[48:51], s69 offen offset:1024 nt
  v_mfma_f32_16x16x32_bf16 v[20:23], v[16:19], v[148:151], v[20:23]
  buffer_load_dwordx4 v[220:223], v1, s[48:51], s69 offen offset:2048 nt
  buffer_load_dwordx4 v[216:219], v1, s[48:51], s69 offen offset:3072 nt
  s_add_u32 s69, s69, 16384
  buffer_load_dwordx4 v[196:199], v3, s[56:59], s71 offen nt
  s_add_u32 s71, s71, 5120
  buffer_load_dwordx4 v[192:195], v3, s[56:59], s71 offen nt
  s_add_u32 s71, s71, 5120
L_hop2606:
  s_cbranch_execz L_hop2623
  s_waitcnt vmcnt(14)
  v_and_b32_dpp v12, v50, v4 row_newbcast:0 row_mask:0xf bank_mask:0xf
  v_and_b32_dpp v13, v50, v5 row_newbcast:0 row_mask:0xf bank_mask:0xf
  v_and_b32_dpp v14, v50, v6 row_newbcast:0 row_mask:0xf bank_mask:0xf
  v_and_b32_dpp v15, v50, v7 row_newbcast:0 row_mask:0xf bank_mask:0xf
  v_and_b32_dpp v16, v50, v4 row_newbcast:8 row_mask:0xf bank_mask:0xf
  v_and_b32_dpp v17, v50, v5 row_newbcast:8 row_mask:0xf bank_mask:0xf
  v_and_b32_dpp v18, v50, v6 row_newbcast:8 row_mask:0xf bank_mask:0xf
  v_and_b32_dpp v19, v50, v7 row_newbcast:8 row_mask:0xf bank_mask:0xf
  v_mfma_f32_16x16x32_bf16 v[20:23], v[12:15], v[152:155], v[20:23]
  v_and_b32_dpp v12, v50, v4 row_newbcast:4 row_mask:0xf bank_mask:0xf
  v_and_b32_dpp v13, v50, v5 row_newbcast:4 row_mask:0xf bank_mask:0xf
  v_and_b32_dpp v14, v50, v6 row_newbcast:4 row_mask:0xf bank_mask:0xf
  v_and_b32_dpp v15, v50, v7 row_newbcast:4 row_mask:0xf bank_mask:0xf
  v_mfma_f32_16x16x32_bf16 v[20:23], v[16:19], v[156:159], v[20:23]
  v_and_b32_dpp v16, v50, v4 row_newbcast:12 row_mask:0xf bank_mask:0xf
L_hop2623:
  s_cbranch_execz L_hop2644
  v_and_b32_dpp v17, v50, v5 row_newbcast:12 row_mask:0xf bank_mask:0xf
  v_and_b32_dpp v18, v50, v6 row_newbcast:12 row_mask:0xf bank_mask:0xf
  v_and_b32_dpp v19, v50, v7 row_newbcast:12 row_mask:0xf bank_mask:0xf
  v_mfma_f32_16x16x32_bf16 v[20:23], v[12:15], v[160:163], v[20:23]
L_gl74:
  s_memrealtime s[30:31]
  s_waitcnt lgkmcnt(0)
  s_sub_u32 s29, s30, s28
  s_cmp_lt_u32 s29, 2347
  s_cbranch_scc0 L_gk73
  s_sleep 1
  s_branch L_gl74
L_gk73:
  buffer_load_dwordx4 v[188:191], v1, s[48:51], s69 offen offset:0 nt
  buffer_load_dwordx4 v[184:187], v1, s[48:51], s69 offen offset:1024 nt
  v_mfma_f32_16x16x32_bf16 v[20:23], v[16:19], v[164:167], v[20:23]
  buffer_load_dwordx4 v[232:235], v1, s[48:51], s69 offen offset:2048 nt
  buffer_load_dwordx4 v[236:239], v1, s[48:51], s69 offen offset:3072 nt
  s_add_u32 s69, s69, 16384
  buffer_load_dwordx4 v[240:243], v3, s[56:59], s71 offen nt
L_hop2644:
  s_cbranch_execz L_hop2661
  s_add_u32 s71, s71, 5120
  buffer_load_dwordx4 v[244:247], v3, s[56:59], s71 offen nt
  s_add_u32 s71, s71, 5120
  s_waitcnt vmcnt(16)
  v_and_b32_dpp v12, v51, v4 row_newbcast:0 row_mask:0xf bank_mask:0xf
  v_and_b32_dpp v13, v51, v5 row_newbcast:0 row_mask:0xf bank_mask:0xf
  v_and_b32_dpp v14, v51, v6 row_newbcast:0 row_mask:0xf bank_mask:0xf
  v_and_b32_dpp v15, v51, v7 row_newbcast:0 row_mask:0xf bank_mask:0xf
  v_and_b32_dpp v16, v51, v4 row_newbcast:8 row_mask:0xf bank_mask:0xf
  v_and_b32_dpp v17, v51, v5 row_newbcast:8 row_mask:0xf bank_mask:0xf
  v_and_b32_dpp v18, v51, v6 row_newbcast:8 row_mask:0xf bank_mask:0xf
  v_and_b32_dpp v19, v51, v7 row_newbcast:8 row_mask:0xf bank_mask:0xf
  v_mfma_f32_16x16x32_bf16 v[20:23], v[12:15], v[168:171], v[20:23]
  v_and_b32_dpp v12, v51, v4 row_newbcast:4 row_mask:0xf bank_mask:0xf
  v_and_b32_dpp v13, v51, v5 row_newbcast:4 row_mask:0xf bank_mask:0xf
  v_and_b32_dpp v14, v51, v6 row_newbcast:4 row_mask:0xf bank_mask:0xf
L_hop2661:
  s_cbranch_execz L_hop2682
  v_and_b32_dpp v15, v51, v7 row_newbcast:4 row_mask:0xf bank_mask:0xf
  v_mfma_f32_16x16x32_bf16 v[20:23], v[16:19], v[172:175], v[20:23]
  v_and_b32_dpp v16, v51, v4 row_newbcast:12 row_mask:0xf bank_mask:0xf
  v_and_b32_dpp v17, v51, v5 row_newbcast:12 row_mask:0xf bank_mask:0xf
  v_and_b32_dpp v18, v51, v6 row_newbcast:12 row_mask:0xf bank_mask:0xf
  v_and_b32_dpp v19, v51, v7 row_newbcast:12 row_mask:0xf bank_mask:0xf
  v_mfma_f32_16x16x32_bf16 v[20:23], v[12:15], v[176:179], v[20:23]
L_gl76:
  s_memrealtime s[30:31]
  s_waitcnt lgkmcnt(0)
  s_sub_u32 s29, s30, s28
  s_cmp_lt_u32 s29, 2411
  s_cbranch_scc0 L_gk75
  s_sleep 1
  s_branch L_gl76
L_gk75:
  buffer_load_dwordx4 v[248:251], v1, s[48:51], s69 offen offset:0 nt
  buffer_load_dwordx4 v[252:255], v1, s[48:51], s69 offen offset:1024 nt
  v_mfma_f32_16x16x32_bf16 v[20:23], v[16:19], v[180:183], v[20:23]
  buffer_load_dwordx4 v[80:83], v1, s[48:51], s69 offen offset:2048 nt
L_hop2682:
  s_cbranch_execz L_hop2699
  buffer_load_dwordx4 v[84:87], v1, s[48:51], s69 offen offset:3072 nt
  s_add_u32 s69, s69, 16384
  buffer_load_dwordx4 v[88:91], v3, s[56:59], s71 offen nt
  s_add_u32 s71, s71, 5120
  buffer_load_dwordx4 v[92:95], v3, s[56:59], s71 offen nt
  s_add_u32 s71, s71, 5120
  s_waitcnt vmcnt(18)
  v_and_b32_dpp v12, v52, v4 row_newbcast:0 row_mask:0xf bank_mask:0xf
  v_and_b32_dpp v13, v52, v5 row_newbcast:0 row_mask:0xf bank_mask:0xf
  v_and_b32_dpp v14, v52, v6 row_newbcast:0 row_mask:0xf bank_mask:0xf
  v_and_b32_dpp v15, v52, v7 row_newbcast:0 row_mask:0xf bank_mask:0xf
  v_and_b32_dpp v16, v52, v4 row_newbcast:8 row_mask:0xf bank_mask:0xf
  v_and_b32_dpp v17, v52, v5 row_newbcast:8 row_mask:0xf bank_mask:0xf
  v_and_b32_dpp v18, v52, v6 row_newbcast:8 row_mask:0xf bank_mask:0xf
  v_and_b32_dpp v19, v52, v7 row_newbcast:8 row_mask:0xf bank_mask:0xf
  v_mfma_f32_16x16x32_bf16 v[20:23], v[12:15], v[200:203], v[20:23]
L_hop2699:
  s_cbranch_execz L_hop2720
  v_and_b32_dpp v12, v52, v4 row_newbcast:4 row_mask:0xf bank_mask:0xf
  v_and_b32_dpp v13, v52, v5 row_newbcast:4 row_mask:0xf bank_mask:0xf
  v_and_b32_dpp v14, v52, v6 row_newbcast:4 row_mask:0xf bank_mask:0xf
  v_and_b32_dpp v15, v52, v7 row_newbcast:4 row_mask:0xf bank_mask:0xf
  v_mfma_f32_16x16x32_bf16 v[20:23], v[16:19], v[204:207], v[20:23]
  v_and_b32_dpp v16, v52, v4 row_newbcast:12 row_mask:0xf bank_mask:0xf
  v_and_b32_dpp v17, v52, v5 row_newbcast:12 row_mask:0xf bank_mask:0xf
  v_and_b32_dpp v18, v52, v6 row_newbcast:12 row_mask:0xf bank_mask:0xf
  v_and_b32_dpp v19, v52, v7 row_newbcast:12 row_mask:0xf bank_mask:0xf
  v_mfma_f32_16x16x32_bf16 v[20:23], v[12:15], v[208:211], v[20:23]
L_gl78:
  s_memrealtime s[30:31]
  s_waitcnt lgkmcnt(0)
  s_sub_u32 s29, s30, s28
  s_cmp_lt_u32 s29, 2475
  s_cbranch_scc0 L_gk77
  s_sleep 1
  s_branch L_gl78
L_gk77:
  buffer_load_dwordx4 v[96:99], v1, s[48:51], s69 offen offset:0 nt
L_hop2720:
  s_cbranch_execz L_hop2737
  buffer_load_dwordx4 v[100:103], v1, s[48:51], s69 offen offset:1024 nt
  v_mfma_f32_16x16x32_bf16 v[20:23], v[16:19], v[212:215], v[20:23]
  buffer_load_dwordx4 v[104:107], v1, s[48:51], s69 offen offset:2048 nt
  buffer_load_dwordx4 v[108:111], v1, s[48:51], s69 offen offset:3072 nt
  s_add_u32 s69, s69, 16384
  buffer_load_dwordx4 v[112:115], v3, s[56:59], s71 offen nt
  s_add_u32 s71, s71, 5120
  buffer_load_dwordx4 v[116:119], v3, s[56:59], s71 offen nt
  s_add_u32 s71, s71, 5120
  s_waitcnt vmcnt(20)
  v_and_b32_dpp v12, v53, v4 row_newbcast:0 row_mask:0xf bank_mask:0xf
  v_and_b32_dpp v13, v53, v5 row_newbcast:0 row_mask:0xf bank_mask:0xf
  v_and_b32_dpp v14, v53, v6 row_newbcast:0 row_mask:0xf bank_mask:0xf
  v_and_b32_dpp v15, v53, v7 row_newbcast:0 row_mask:0xf bank_mask:0xf
  v_and_b32_dpp v16, v53, v4 row_newbcast:8 row_mask:0xf bank_mask:0xf
  v_and_b32_dpp v17, v53, v5 row_newbcast:8 row_mask:0xf bank_mask:0xf
L_hop2737:
  s_cbranch_execz L_hop2760
  v_and_b32_dpp v18, v53, v6 row_newbcast:8 row_mask:0xf bank_mask:0xf
  v_and_b32_dpp v19, v53, v7 row_newbcast:8 row_mask:0xf bank_mask:0xf
  v_mfma_f32_16x16x32_bf16 v[20:23], v[12:15], v[228:231], v[20:23]
  v_and_b32_dpp v12, v53, v4 row_newbcast:4 row_mask:0xf bank_mask:0xf
  v_and_b32_dpp v13, v53, v5 row_newbcast:4 row_mask:0xf bank_mask:0xf
  v_and_b32_dpp v14, v53, v6 row_newbcast:4 row_mask:0xf bank_mask:0xf
  v_and_b32_dpp v15, v53, v7 row_newbcast:4 row_mask:0xf bank_mask:0xf
  v_mfma_f32_16x16x32_bf16 v[20:23], v[16:19], v[224:227], v[20:23]
  v_and_b32_dpp v16, v53, v4 row_newbcast:12 row_mask:0xf bank_mask:0xf
  v_and_b32_dpp v17, v53, v5 row_newbcast:12 row_mask:0xf bank_mask:0xf
  v_and_b32_dpp v18, v53, v6 row_newbcast:12 row_mask:0xf bank_mask:0xf
  v_and_b32_dpp v19, v53, v7 row_newbcast:12 row_mask:0xf bank_mask:0xf
  v_mfma_f32_16x16x32_bf16 v[20:23], v[12:15], v[220:223], v[20:23]
L_gl80:
  s_memrealtime s[30:31]
  s_waitcnt lgkmcnt(0)
  s_sub_u32 s29, s30, s28
  s_cmp_lt_u32 s29, 2539
  s_cbranch_scc0 L_gk79
  s_sleep 1
  s_branch L_gl80
L_gk79:
L_hop2760:
  s_cbranch_execz L_hop2775
  buffer_load_dwordx4 v[120:123], v1, s[48:51], s69 offen offset:0 nt
  buffer_load_dwordx4 v[124:127], v1, s[48:51], s69 offen offset:1024 nt
  v_mfma_f32_16x16x32_bf16 v[20:23], v[16:19], v[216:219], v[20:23]
  buffer_load_dwordx4 v[128:131], v1, s[48:51], s69 offen offset:2048 nt
  buffer_load_dwordx4 v[132:135], v1, s[48:51], s69 offen offset:3072 nt
  s_add_u32 s69, s69, 16384
  buffer_load_dwordx4 v[136:139], v3, s[56:59], s71 offen nt
  s_add_u32 s71, s71, 5120
  buffer_load_dwordx4 v[140:143], v3, s[56:59], s71 offen nt
  s_add_u32 s71, s71, 5120
  s_waitcnt vmcnt(20)
  v_and_b32_dpp v12, v54, v4 row_newbcast:0 row_mask:0xf bank_mask:0xf
  v_and_b32_dpp v13, v54, v5 row_newbcast:0 row_mask:0xf bank_mask:0xf
  v_and_b32_dpp v14, v54, v6 row_newbcast:0 row_mask:0xf bank_mask:0xf
L_hop2775:
  s_cbranch_execz L_hop2791
  v_and_b32_dpp v15, v54, v7 row_newbcast:0 row_mask:0xf bank_mask:0xf
  v_and_b32_dpp v16, v54, v4 row_newbcast:8 row_mask:0xf bank_mask:0xf
  v_and_b32_dpp v17, v54, v5 row_newbcast:8 row_mask:0xf bank_mask:0xf
  v_and_b32_dpp v18, v54, v6 row_newbcast:8 row_mask:0xf bank_mask:0xf
  v_and_b32_dpp v19, v54, v7 row_newbcast:8 row_mask:0xf bank_mask:0xf
  v_mfma_f32_16x16x32_bf16 v[20:23], v[12:15], v[188:191], v[20:23]
  v_and_b32_dpp v12, v54, v4 row_newbcast:4 row_mask:0xf bank_mask:0xf
  v_and_b32_dpp v13, v54, v5 row_newbcast:4 row_mask:0xf bank_mask:0xf
  v_and_b32_dpp v14, v54, v6 row_newbcast:4 row_mask:0xf bank_mask:0xf
  v_and_b32_dpp v15, v54, v7 row_newbcast:4 row_mask:0xf bank_mask:0xf
  v_mfma_f32_16x16x32_bf16 v[20:23], v[16:19], v[184:187], v[20:23]
  v_and_b32_dpp v16, v54, v4 row_newbcast:12 row_mask:0xf bank_mask:0xf
  v_and_b32_dpp v17, v54, v5 row_newbcast:12 row_mask:0xf bank_mask:0xf
  v_and_b32_dpp v18, v54, v6 row_newbcast:12 row_mask:0xf bank_mask:0xf
  v_and_b32_dpp v19, v54, v7 row_newbcast:12 row_mask:0xf bank_mask:0xf
L_hop2791:
  s_cbranch_execz L_hop2812
  v_mfma_f32_16x16x32_bf16 v[20:23], v[12:15], v[232:235], v[20:23]
L_gl82:
  s_memrealtime s[30:31]
  s_waitcnt lgkmcnt(0)
  s_sub_u32 s29, s30, s28
  s_cmp_lt_u32 s29, 2603
  s_cbranch_scc0 L_gk81
  s_sleep 1
  s_branch L_gl82
L_gk81:
  buffer_load_dwordx4 v[144:147], v1, s[48:51], s69 offen offset:0 nt
  buffer_load_dwordx4 v[148:151], v1, s[48:51], s69 offen offset:1024 nt
  v_mfma_f32_16x16x32_bf16 v[20:23], v[16:19], v[236:239], v[20:23]
  buffer_load_dwordx4 v[152:155], v1, s[48:51], s69 offen offset:2048 nt
  buffer_load_dwordx4 v[156:159], v1, s[48:51], s69 offen offset:3072 nt
  s_add_u32 s69, s69, 16384
  buffer_load_dwordx4 v[160:163], v3, s[56:59], s71 offen nt
  s_add_u32 s71, s71, 5120
  buffer_load_dwordx4 v[164:167], v3, s[56:59], s71 offen nt
  s_add_u32 s71, s71, 5120
L_hop2812:
  s_cbranch_execz L_hop2829
  s_waitcnt vmcnt(20)
  v_and_b32_dpp v12, v55, v4 row_newbcast:0 row_mask:0xf bank_mask:0xf
  v_and_b32_dpp v13, v55, v5 row_newbcast:0 row_mask:0xf bank_mask:0xf
  v_and_b32_dpp v14, v55, v6 row_newbcast:0 row_mask:0xf bank_mask:0xf
  v_and_b32_dpp v15, v55, v7 row_newbcast:0 row_mask:0xf bank_mask:0xf
  v_and_b32_dpp v16, v55, v4 row_newbcast:8 row_mask:0xf bank_mask:0xf
  v_and_b32_dpp v17, v55, v5 row_newbcast:8 row_mask:0xf bank_mask:0xf
  v_and_b32_dpp v18, v55, v6 row_newbcast:8 row_mask:0xf bank_mask:0xf
  v_and_b32_dpp v19, v55, v7 row_newbcast:8 row_mask:0xf bank_mask:0xf
  v_mfma_f32_16x16x32_bf16 v[20:23], v[12:15], v[248:251], v[20:23]
  v_and_b32_dpp v12, v55, v4 row_newbcast:4 row_mask:0xf bank_mask:0xf
  v_and_b32_dpp v13, v55, v5 row_newbcast:4 row_mask:0xf bank_mask:0xf
  v_and_b32_dpp v14, v55, v6 row_newbcast:4 row_mask:0xf bank_mask:0xf
  v_and_b32_dpp v15, v55, v7 row_newbcast:4 row_mask:0xf bank_mask:0xf
  v_mfma_f32_16x16x32_bf16 v[20:23], v[16:19], v[252:255], v[20:23]
  v_and_b32_dpp v16, v55, v4 row_newbcast:12 row_mask:0xf bank_mask:0xf
L_hop2829:
  s_cbranch_execz L_hop2850
  v_and_b32_dpp v17, v55, v5 row_newbcast:12 row_mask:0xf bank_mask:0xf
  v_and_b32_dpp v18, v55, v6 row_newbcast:12 row_mask:0xf bank_mask:0xf
  v_and_b32_dpp v19, v55, v7 row_newbcast:12 row_mask:0xf bank_mask:0xf
  v_mfma_f32_16x16x32_bf16 v[20:23], v[12:15], v[80:83], v[20:23]
L_gl84:
  s_memrealtime s[30:31]
  s_waitcnt lgkmcnt(0)
  s_sub_u32 s29, s30, s28
  s_cmp_lt_u32 s29, 2667
  s_cbranch_scc0 L_gk83
  s_sleep 1
  s_branch L_gl84
L_gk83:
  buffer_load_dwordx4 v[168:171], v1, s[48:51], s69 offen offset:0 nt
  buffer_load_dwordx4 v[172:175], v1, s[48:51], s69 offen offset:1024 nt
  v_mfma_f32_16x16x32_bf16 v[20:23], v[16:19], v[84:87], v[20:23]
  buffer_load_dwordx4 v[176:179], v1, s[48:51], s69 offen offset:2048 nt
  buffer_load_dwordx4 v[180:183], v1, s[48:51], s69 offen offset:3072 nt
  s_add_u32 s69, s69, 16384
  buffer_load_dwordx4 v[48:51], v3, s[56:59], s71 offen nt
L_hop2850:
  s_cbranch_execz L_wret1
  s_add_u32 s71, s71, 5120
  buffer_load_dwordx4 v[200:203], v3, s[56:59], s71 offen nt
  s_add_u32 s71, s71, 5120
L_wseg2:
L_hop2854:
  s_cbranch_execz L_hop2868
  s_waitcnt vmcnt(20)
  v_and_b32_dpp v12, v56, v4 row_newbcast:0 row_mask:0xf bank_mask:0xf
  v_and_b32_dpp v13, v56, v5 row_newbcast:0 row_mask:0xf bank_mask:0xf
  v_and_b32_dpp v14, v56, v6 row_newbcast:0 row_mask:0xf bank_mask:0xf
  v_and_b32_dpp v15, v56, v7 row_newbcast:0 row_mask:0xf bank_mask:0xf
  v_and_b32_dpp v16, v56, v4 row_newbcast:8 row_mask:0xf bank_mask:0xf
  v_and_b32_dpp v17, v56, v5 row_newbcast:8 row_mask:0xf bank_mask:0xf
  v_and_b32_dpp v18, v56, v6 row_newbcast:8 row_mask:0xf bank_mask:0xf
  v_and_b32_dpp v19, v56, v7 row_newbcast:8 row_mask:0xf bank_mask:0xf
  v_mfma_f32_16x16x32_bf16 v[20:23], v[12:15], v[96:99], v[20:23]
  v_and_b32_dpp v12, v56, v4 row_newbcast:4 row_mask:0xf bank_mask:0xf
  v_and_b32_dpp v13, v56, v5 row_newbcast:4 row_mask:0xf bank_mask:0xf
  v_and_b32_dpp v14, v56, v6 row_newbcast:4 row_mask:0xf bank_mask:0xf
L_hop2868:
  s_cbranch_execz L_hop2889
  v_and_b32_dpp v15, v56, v7 row_newbcast:4 row_mask:0xf bank_mask:0xf
  v_mfma_f32_16x16x32_bf16 v[20:23], v[16:19], v[100:103], v[20:23]
  v_and_b32_dpp v16, v56, v4 row_newbcast:12 row_mask:0xf bank_mask:0xf
  v_and_b32_dpp v17, v56, v5 row_newbcast:12 row_mask:0xf bank_mask:0xf
  v_and_b32_dpp v18, v56, v6 row_newbcast:12 row_mask:0xf bank_mask:0xf
  v_and_b32_dpp v19, v56, v7 row_newbcast:12 row_mask:0xf bank_mask:0xf
  v_mfma_f32_16x16x32_bf16 v[20:23], v[12:15], v[104:107], v[20:23]
L_gl86:
  s_memrealtime s[30:31]
  s_waitcnt lgkmcnt(0)
  s_sub_u32 s29, s30, s28
  s_cmp_lt_u32 s29, 2732
  s_cbranch_scc0 L_gk85
  s_sleep 1
  s_branch L_gl86
L_gk85:
  buffer_load_dwordx4 v[204:207], v1, s[48:51], s69 offen offset:0 nt
  buffer_load_dwordx4 v[208:211], v1, s[48:51], s69 offen offset:1024 nt
  v_mfma_f32_16x16x32_bf16 v[20:23], v[16:19], v[108:111], v[20:23]
  buffer_load_dwordx4 v[212:215], v1, s[48:51], s69 offen offset:2048 nt
L_hop2889:
  s_cbranch_execz L_hop2906
  buffer_load_dwordx4 v[228:231], v1, s[48:51], s69 offen offset:3072 nt
  s_add_u32 s69, s69, 16384
  buffer_load_dwordx4 v[224:227], v3, s[56:59], s71 offen nt
  s_add_u32 s71, s71, 5120
  buffer_load_dwordx4 v[220:223], v3, s[56:59], s71 offen nt
  s_add_u32 s71, s71, 5120
  s_waitcnt vmcnt(20)
  v_and_b32_dpp v12, v57, v4 row_newbcast:0 row_mask:0xf bank_mask:0xf
  v_and_b32_dpp v13, v57, v5 row_newbcast:0 row_mask:0xf bank_mask:0xf
  v_and_b32_dpp v14, v57, v6 row_newbcast:0 row_mask:0xf bank_mask:0xf
  v_and_b32_dpp v15, v57, v7 row_newbcast:0 row_mask:0xf bank_mask:0xf
  v_and_b32_dpp v16, v57, v4 row_newbcast:8 row_mask:0xf bank_mask:0xf
  v_and_b32_dpp v17, v57, v5 row_newbcast:8 row_mask:0xf bank_mask:0xf
  v_and_b32_dpp v18, v57, v6 row_newbcast:8 row_mask:0xf bank_mask:0xf
  v_and_b32_dpp v19, v57, v7 row_newbcast:8 row_mask:0xf bank_mask:0xf
  v_mfma_f32_16x16x32_bf16 v[20:23], v[12:15], v[120:123], v[20:23]
L_hop2906:
  s_cbranch_execz L_hop2927
  v_and_b32_dpp v12, v57, v4 row_newbcast:4 row_mask:0xf bank_mask:0xf
  v_and_b32_dpp v13, v57, v5 row_newbcast:4 row_mask:0xf bank_mask:0xf
  v_and_b32_dpp v14, v57, v6 row_newbcast:4 row_mask:0xf bank_mask:0xf
  v_and_b32_dpp v15, v57, v7 row_newbcast:4 row_mask:0xf bank_mask:0xf
  v_mfma_f32_16x16x32_bf16 v[20:23], v[16:19], v[124:127], v[20:23]
  v_and_b32_dpp v16, v57, v4 row_newbcast:12 row_mask:0xf bank_mask:0xf
  v_and_b32_dpp v17, v57, v5 row_newbcast:12 row_mask:0xf bank_mask:0xf
  v_and_b32_dpp v18, v57, v6 row_newbcast:12 row_mask:0xf bank_mask:0xf
  v_and_b32_dpp v19, v57, v7 row_newbcast:12 row_mask:0xf bank_mask:0xf
  v_mfma_f32_16x16x32_bf16 v[20:23], v[12:15], v[128:131], v[20:23]
L_gl88:
  s_memrealtime s[30:31]
  s_waitcnt lgkmcnt(0)
  s_sub_u32 s29, s30, s28
  s_cmp_lt_u32 s29, 2796
  s_cbranch_scc0 L_gk87
  s_sleep 1
  s_branch L_gl88
L_gk87:
  buffer_load_dwordx4 v[216:219], v1, s[48:51], s69 offen offset:0 nt
L_hop2927:
  s_cbranch_execz L_hop2944
  buffer_load_dwordx4 v[188:191], v1, s[48:51], s69 offen offset:1024 nt
  v_mfma_f32_16x16x32_bf16 v[20:23], v[16:19], v[132:135], v[20:23]
  buffer_load_dwordx4 v[184:187], v1, s[48:51], s69 offen offset:2048 nt
  buffer_load_dwordx4 v[232:235], v1, s[48:51], s69 offen offset:3072 nt
  s_add_u32 s69, s69, 16384
  buffer_load_dwordx4 v[236:239], v3, s[56:59], s71 offen nt
  s_add_u32 s71, s71, 5120
  buffer_load_dwordx4 v[248:251], v3, s[56:59], s71 offen nt
  s_add_u32 s71, s71, 5120
  s_waitcnt vmcnt(20)
  v_and_b32_dpp v12, v58, v4 row_newbcast:0 row_mask:0xf bank_mask:0xf
  v_and_b32_dpp v13, v58, v5 row_newbcast:0 row_mask:0xf bank_mask:0xf
  v_and_b32_dpp v14, v58, v6 row_newbcast:0 row_mask:0xf bank_mask:0xf
  v_and_b32_dpp v15, v58, v7 row_newbcast:0 row_mask:0xf bank_mask:0xf
  v_and_b32_dpp v16, v58, v4 row_newbcast:8 row_mask:0xf bank_mask:0xf
  v_and_b32_dpp v17, v58, v5 row_newbcast:8 row_mask:0xf bank_mask:0xf
L_hop2944:
  s_cbranch_execz L_hop2967
  v_and_b32_dpp v18, v58, v6 row_newbcast:8 row_mask:0xf bank_mask:0xf
  v_and_b32_dpp v19, v58, v7 row_newbcast:8 row_mask:0xf bank_mask:0xf
  v_mfma_f32_16x16x32_bf16 v[20:23], v[12:15], v[144:147], v[20:23]
  v_and_b32_dpp v12, v58, v4 row_newbcast:4 row_mask:0xf bank_mask:0xf
  v_and_b32_dpp v13, v58, v5 row_newbcast:4 row_mask:0xf bank_mask:0xf
  v_and_b32_dpp v14, v58, v6 row_newbcast:4 row_mask:0xf bank_mask:0xf
  v_and_b32_dpp v15, v58, v7 row_newbcast:4 row_mask:0xf bank_mask:0xf
  v_mfma_f32_16x16x32_bf16 v[20:23], v[16:19], v[148:151], v[20:23]
  v_and_b32_dpp v16, v58, v4 row_newbcast:12 row_mask:0xf bank_mask:0xf
  v_and_b32_dpp v17, v58, v5 row_newbcast:12 row_mask:0xf bank_mask:0xf
  v_and_b32_dpp v18, v58, v6 row_newbcast:12 row_mask:0xf bank_mask:0xf
  v_and_b32_dpp v19, v58, v7 row_newbcast:12 row_mask:0xf bank_mask:0xf
  v_mfma_f32_16x16x32_bf16 v[20:23], v[12:15], v[152:155], v[20:23]
L_gl90:
  s_memrealtime s[30:31]
  s_waitcnt lgkmcnt(0)
  s_sub_u32 s29, s30, s28
  s_cmp_lt_u32 s29, 2860
  s_cbranch_scc0 L_gk89
  s_sleep 1
  s_branch L_gl90
L_gk89:
L_hop2967:
  s_cbranch_execz L_hop2982
  buffer_load_dwordx4 v[252:255], v1, s[48:51], s69 offen offset:0 nt
  buffer_load_dwordx4 v[80:83], v1, s[48:51], s69 offen offset:1024 nt
  v_mfma_f32_16x16x32_bf16 v[20:23], v[16:19], v[156:159], v[20:23]
  buffer_load_dwordx4 v[84:87], v1, s[48:51], s69 offen offset:2048 nt
  buffer_load_dwordx4 v[52:55], v1, s[48:51], s69 offen offset:3072 nt
  s_add_u32 s69, s69, 16384
  buffer_load_dwordx4 v[96:99], v3, s[56:59], s71 offen nt
  s_add_u32 s71, s71, 5120
  buffer_load_dwordx4 v[100:103], v3, s[56:59], s71 offen nt
  s_add_u32 s71, s71, 5120
  s_waitcnt vmcnt(20)
  v_and_b32_dpp v12, v59, v4 row_newbcast:0 row_mask:0xf bank_mask:0xf
  v_and_b32_dpp v13, v59, v5 row_newbcast:0 row_mask:0xf bank_mask:0xf
  v_and_b32_dpp v14, v59, v6 row_newbcast:0 row_mask:0xf bank_mask:0xf
L_hop2982:
  s_cbranch_execz L_hop2998
  v_and_b32_dpp v15, v59, v7 row_newbcast:0 row_mask:0xf bank_mask:0xf
  v_and_b32_dpp v16, v59, v4 row_newbcast:8 row_mask:0xf bank_mask:0xf
  v_and_b32_dpp v17, v59, v5 row_newbcast:8 row_mask:0xf bank_mask:0xf
  v_and_b32_dpp v18, v59, v6 row_newbcast:8 row_mask:0xf bank_mask:0xf
  v_and_b32_dpp v19, v59, v7 row_newbcast:8 row_mask:0xf bank_mask:0xf
  v_mfma_f32_16x16x32_bf16 v[20:23], v[12:15], v[168:171], v[20:23]
  v_and_b32_dpp v12, v59, v4 row_newbcast:4 row_mask:0xf bank_mask:0xf
  v_and_b32_dpp v13, v59, v5 row_newbcast:4 row_mask:0xf bank_mask:0xf
  v_and_b32_dpp v14, v59, v6 row_newbcast:4 row_mask:0xf bank_mask:0xf
  v_and_b32_dpp v15, v59, v7 row_newbcast:4 row_mask:0xf bank_mask:0xf
  v_mfma_f32_16x16x32_bf16 v[20:23], v[16:19], v[172:175], v[20:23]
  v_and_b32_dpp v16, v59, v4 row_newbcast:12 row_mask:0xf bank_mask:0xf
  v_and_b32_dpp v17, v59, v5 row_newbcast:12 row_mask:0xf bank_mask:0xf
  v_and_b32_dpp v18, v59, v6 row_newbcast:12 row_mask:0xf bank_mask:0xf
  v_and_b32_dpp v19, v59, v7 row_newbcast:12 row_mask:0xf bank_mask:0xf
L_hop2998:
  s_cbranch_execz L_hop3019
  v_mfma_f32_16x16x32_bf16 v[20:23], v[12:15], v[176:179], v[20:23]
L_gl92:
  s_memrealtime s[30:31]
  s_waitcnt lgkmcnt(0)
  s_sub_u32 s29, s30, s28
  s_cmp_lt_u32 s29, 2924
  s_cbranch_scc0 L_gk91
  s_sleep 1
  s_branch L_gl92
L_gk91:
  buffer_load_dwordx4 v[104:107], v1, s[48:51], s69 offen offset:0 nt
  buffer_load_dwordx4 v[108:111], v1, s[48:51], s69 offen offset:1024 nt
  v_mfma_f32_16x16x32_bf16 v[20:23], v[16:19], v[180:183], v[20:23]
  buffer_load_dwordx4 v[120:123], v1, s[48:51], s69 offen offset:2048 nt
  buffer_load_dwordx4 v[124:127], v1, s[48:51], s69 offen offset:3072 nt
  s_add_u32 s69, s69, 16384
  buffer_load_dwordx4 v[128:131], v3, s[56:59], s71 offen nt
  s_add_u32 s71, s71, 5120
  buffer_load_dwordx4 v[132:135], v3, s[56:59], s71 offen nt
  s_add_u32 s71, s71, 5120
L_hop3019:
  s_cbranch_execz L_hop3036
  s_waitcnt vmcnt(20)
  v_and_b32_dpp v12, v60, v4 row_newbcast:0 row_mask:0xf bank_mask:0xf
  v_and_b32_dpp v13, v60, v5 row_newbcast:0 row_mask:0xf bank_mask:0xf
  v_and_b32_dpp v14, v60, v6 row_newbcast:0 row_mask:0xf bank_mask:0xf
  v_and_b32_dpp v15, v60, v7 row_newbcast:0 row_mask:0xf bank_mask:0xf
  v_and_b32_dpp v16, v60, v4 row_newbcast:8 row_mask:0xf bank_mask:0xf
  v_and_b32_dpp v17, v60, v5 row_newbcast:8 row_mask:0xf bank_mask:0xf
  v_and_b32_dpp v18, v60, v6 row_newbcast:8 row_mask:0xf bank_mask:0xf
  v_and_b32_dpp v19, v60, v7 row_newbcast:8 row_mask:0xf bank_mask:0xf
  v_mfma_f32_16x16x32_bf16 v[20:23], v[12:15], v[204:207], v[20:23]
  v_and_b32_dpp v12, v60, v4 row_newbcast:4 row_mask:0xf bank_mask:0xf
  v_and_b32_dpp v13, v60, v5 row_newbcast:4 row_mask:0xf bank_mask:0xf
  v_and_b32_dpp v14, v60, v6 row_newbcast:4 row_mask:0xf bank_mask:0xf
  v_and_b32_dpp v15, v60, v7 row_newbcast:4 row_mask:0xf bank_mask:0xf
  v_mfma_f32_16x16x32_bf16 v[20:23], v[16:19], v[208:211], v[20:23]
  v_and_b32_dpp v16, v60, v4 row_newbcast:12 row_mask:0xf bank_mask:0xf
L_hop3036:
  s_cbranch_execz L_hop3057
  v_and_b32_dpp v17, v60, v5 row_newbcast:12 row_mask:0xf bank_mask:0xf
  v_and_b32_dpp v18, v60, v6 row_newbcast:12 row_mask:0xf bank_mask:0xf
  v_and_b32_dpp v19, v60, v7 row_newbcast:12 row_mask:0xf bank_mask:0xf
  v_mfma_f32_16x16x32_bf16 v[20:23], v[12:15], v[212:215], v[20:23]
L_gl94:
  s_memrealtime s[30:31]
  s_waitcnt lgkmcnt(0)
  s_sub_u32 s29, s30, s28
  s_cmp_lt_u32 s29, 2988
  s_cbranch_scc0 L_gk93
  s_sleep 1
  s_branch L_gl94
L_gk93:
  buffer_load_dwordx4 v[144:147], v1, s[48:51], s69 offen offset:0 nt
  buffer_load_dwordx4 v[148:151], v1, s[48:51], s69 offen offset:1024 nt
  v_mfma_f32_16x16x32_bf16 v[20:23], v[16:19], v[228:231], v[20:23]
  buffer_load_dwordx4 v[152:155], v1, s[48:51], s69 offen offset:2048 nt
  buffer_load_dwordx4 v[156:159], v1, s[48:51], s69 offen offset:3072 nt
  s_add_u32 s69, s69, 16384
  buffer_load_dwordx4 v[168:171], v3, s[56:59], s71 offen nt
L_hop3057:
  s_cbranch_execz L_hop3074
  s_add_u32 s71, s71, 5120
  buffer_load_dwordx4 v[172:175], v3, s[56:59], s71 offen nt
  s_add_u32 s71, s71, 5120
  s_waitcnt vmcnt(20)
  v_and_b32_dpp v12, v61, v4 row_newbcast:0 row_mask:0xf bank_mask:0xf
  v_and_b32_dpp v13, v61, v5 row_newbcast:0 row_mask:0xf bank_mask:0xf
  v_and_b32_dpp v14, v61, v6 row_newbcast:0 row_mask:0xf bank_mask:0xf
  v_and_b32_dpp v15, v61, v7 row_newbcast:0 row_mask:0xf bank_mask:0xf
  v_and_b32_dpp v16, v61, v4 row_newbcast:8 row_mask:0xf bank_mask:0xf
  v_and_b32_dpp v17, v61, v5 row_newbcast:8 row_mask:0xf bank_mask:0xf
  v_and_b32_dpp v18, v61, v6 row_newbcast:8 row_mask:0xf bank_mask:0xf
  v_and_b32_dpp v19, v61, v7 row_newbcast:8 row_mask:0xf bank_mask:0xf
  v_mfma_f32_16x16x32_bf16 v[20:23], v[12:15], v[216:219], v[20:23]
  v_and_b32_dpp v12, v61, v4 row_newbcast:4 row_mask:0xf bank_mask:0xf
  v_and_b32_dpp v13, v61, v5 row_newbcast:4 row_mask:0xf bank_mask:0xf
  v_and_b32_dpp v14, v61, v6 row_newbcast:4 row_mask:0xf bank_mask:0xf
L_hop3074:
  s_cbranch_execz L_hop3095
  v_and_b32_dpp v15, v61, v7 row_newbcast:4 row_mask:0xf bank_mask:0xf
  v_mfma_f32_16x16x32_bf16 v[20:23], v[16:19], v[188:191], v[20:23]
  v_and_b32_dpp v16, v61, v4 row_newbcast:12 row_mask:0xf bank_mask:0xf
  v_and_b32_dpp v17, v61, v5 row_newbcast:12 row_mask:0xf bank_mask:0xf
  v_and_b32_dpp v18, v61, v6 row_newbcast:12 row_mask:0xf bank_mask:0xf
  v_and_b32_dpp v19, v61, v7 row_newbcast:12 row_mask:0xf bank_mask:0xf
  v_mfma_f32_16x16x32_bf16 v[20:23], v[12:15], v[184:187], v[20:23]
L_gl96:
  s_memrealtime s[30:31]
  s_waitcnt lgkmcnt(0)
  s_sub_u32 s29, s30, s28
  s_cmp_lt_u32 s29, 3052
  s_cbranch_scc0 L_gk95
  s_sleep 1
  s_branch L_gl96
L_gk95:
  buffer_load_dwordx4 v[176:179], v1, s[48:51], s69 offen offset:0 nt
  buffer_load_dwordx4 v[180:183], v1, s[48:51], s69 offen offset:1024 nt
  v_mfma_f32_16x16x32_bf16 v[20:23], v[16:19], v[232:235], v[20:23]
  buffer_load_dwordx4 v[56:59], v1, s[48:51], s69 offen offset:2048 nt
L_hop3095:
  s_cbranch_execz L_hop3112
  buffer_load_dwordx4 v[204:207], v1, s[48:51], s69 offen offset:3072 nt
  s_add_u32 s69, s69, 16384
  buffer_load_dwordx4 v[208:211], v3, s[56:59], s71 offen nt
  s_add_u32 s71, s71, 5120
  buffer_load_dwordx4 v[212:215], v3, s[56:59], s71 offen nt
  s_add_u32 s71, s71, 5120
  s_waitcnt vmcnt(20)
  v_and_b32_dpp v12, v62, v4 row_newbcast:0 row_mask:0xf bank_mask:0xf
  v_and_b32_dpp v13, v62, v5 row_newbcast:0 row_mask:0xf bank_mask:0xf
  v_and_b32_dpp v14, v62, v6 row_newbcast:0 row_mask:0xf bank_mask:0xf
  v_and_b32_dpp v15, v62, v7 row_newbcast:0 row_mask:0xf bank_mask:0xf
  v_and_b32_dpp v16, v62, v4 row_newbcast:8 row_mask:0xf bank_mask:0xf
  v_and_b32_dpp v17, v62, v5 row_newbcast:8 row_mask:0xf bank_mask:0xf
  v_and_b32_dpp v18, v62, v6 row_newbcast:8 row_mask:0xf bank_mask:0xf
  v_and_b32_dpp v19, v62, v7 row_newbcast:8 row_mask:0xf bank_mask:0xf
  v_mfma_f32_16x16x32_bf16 v[20:23], v[12:15], v[252:255], v[20:23]
L_hop3112:
  s_cbranch_execz L_hop3133
  v_and_b32_dpp v12, v62, v4 row_newbcast:4 row_mask:0xf bank_mask:0xf
  v_and_b32_dpp v13, v62, v5 row_newbcast:4 row_mask:0xf bank_mask:0xf
  v_and_b32_dpp v14, v62, v6 row_newbcast:4 row_mask:0xf bank_mask:0xf
  v_and_b32_dpp v15, v62, v7 row_newbcast:4 row_mask:0xf bank_mask:0xf
  v_mfma_f32_16x16x32_bf16 v[20:23], v[16:19], v[80:83], v[20:23]
  v_and_b32_dpp v16, v62, v4 row_newbcast:12 row_mask:0xf bank_mask:0xf
  v_and_b32_dpp v17, v62, v5 row_newbcast:12 row_mask:0xf bank_mask:0xf
  v_and_b32_dpp v18, v62, v6 row_newbcast:12 row_mask:0xf bank_mask:0xf
  v_and_b32_dpp v19, v62, v7 row_newbcast:12 row_mask:0xf bank_mask:0xf
  v_mfma_f32_16x16x32_bf16 v[20:23], v[12:15], v[84:87], v[20:23]
L_gl98:
  s_memrealtime s[30:31]
  s_waitcnt lgkmcnt(0)
  s_sub_u32 s29, s30, s28
  s_cmp_lt_u32 s29, 3116
  s_cbranch_scc0 L_gk97
  s_sleep 1
  s_branch L_gl98
L_gk97:
  buffer_load_dwordx4 v[228:231], v1, s[48:51], s69 offen offset:0 nt
L_hop3133:
  s_cbranch_execz L_hop3150
  buffer_load_dwordx4 v[216:219], v1, s[48:51], s69 offen offset:1024 nt
  v_mfma_f32_16x16x32_bf16 v[20:23], v[16:19], v[52:55], v[20:23]
  buffer_load_dwordx4 v[188:191], v1, s[48:51], s69 offen offset:2048 nt
  buffer_load_dwordx4 v[184:187], v1, s[48:51], s69 offen offset:3072 nt
  s_add_u32 s69, s69, 16384
  buffer_load_dwordx4 v[232:235], v3, s[56:59], s71 offen nt
  s_add_u32 s71, s71, 5120
  buffer_load_dwordx4 v[252:255], v3, s[56:59], s71 offen nt
  s_add_u32 s71, s71, 5120
  s_waitcnt vmcnt(20)
  v_and_b32_dpp v12, v63, v4 row_newbcast:0 row_mask:0xf bank_mask:0xf
  v_and_b32_dpp v13, v63, v5 row_newbcast:0 row_mask:0xf bank_mask:0xf
  v_and_b32_dpp v14, v63, v6 row_newbcast:0 row_mask:0xf bank_mask:0xf
  v_and_b32_dpp v15, v63, v7 row_newbcast:0 row_mask:0xf bank_mask:0xf
  v_and_b32_dpp v16, v63, v4 row_newbcast:8 row_mask:0xf bank_mask:0xf
  v_and_b32_dpp v17, v63, v5 row_newbcast:8 row_mask:0xf bank_mask:0xf
L_hop3150:
  s_cbranch_execz L_hop3173
  v_and_b32_dpp v18, v63, v6 row_newbcast:8 row_mask:0xf bank_mask:0xf
  v_and_b32_dpp v19, v63, v7 row_newbcast:8 row_mask:0xf bank_mask:0xf
  v_mfma_f32_16x16x32_bf16 v[20:23], v[12:15], v[104:107], v[20:23]
  v_and_b32_dpp v12, v63, v4 row_newbcast:4 row_mask:0xf bank_mask:0xf
  v_and_b32_dpp v13, v63, v5 row_newbcast:4 row_mask:0xf bank_mask:0xf
  v_and_b32_dpp v14, v63, v6 row_newbcast:4 row_mask:0xf bank_mask:0xf
  v_and_b32_dpp v15, v63, v7 row_newbcast:4 row_mask:0xf bank_mask:0xf
  v_mfma_f32_16x16x32_bf16 v[20:23], v[16:19], v[108:111], v[20:23]
  v_and_b32_dpp v16, v63, v4 row_newbcast:12 row_mask:0xf bank_mask:0xf
  v_and_b32_dpp v17, v63, v5 row_newbcast:12 row_mask:0xf bank_mask:0xf
  v_and_b32_dpp v18, v63, v6 row_newbcast:12 row_mask:0xf bank_mask:0xf
  v_and_b32_dpp v19, v63, v7 row_newbcast:12 row_mask:0xf bank_mask:0xf
  v_mfma_f32_16x16x32_bf16 v[20:23], v[12:15], v[120:123], v[20:23]
L_gl100:
  s_memrealtime s[30:31]
  s_waitcnt lgkmcnt(0)
  s_sub_u32 s29, s30, s28
  s_cmp_lt_u32 s29, 3180
  s_cbranch_scc0 L_gk99
  s_sleep 1
  s_branch L_gl100
L_gk99:
L_hop3173:
  s_cbranch_execz L_hop3188
  buffer_load_dwordx4 v[80:83], v1, s[48:51], s69 offen offset:0 nt
  buffer_load_dwordx4 v[84:87], v1, s[48:51], s69 offen offset:1024 nt
  v_mfma_f32_16x16x32_bf16 v[20:23], v[16:19], v[124:127], v[20:23]
  buffer_load_dwordx4 v[52:55], v1, s[48:51], s69 offen offset:2048 nt
  buffer_load_dwordx4 v[104:107], v1, s[48:51], s69 offen offset:3072 nt
  s_add_u32 s69, s69, 16384
  buffer_load_dwordx4 v[108:111], v3, s[56:59], s71 offen nt
  s_add_u32 s71, s71, 5120
  buffer_load_dwordx4 v[120:123], v3, s[56:59], s71 offen nt
  s_add_u32 s71, s71, 5120
  s_waitcnt vmcnt(20)
  v_and_b32_dpp v12, v64, v4 row_newbcast:0 row_mask:0xf bank_mask:0xf
  v_and_b32_dpp v13, v64, v5 row_newbcast:0 row_mask:0xf bank_mask:0xf
  v_and_b32_dpp v14, v64, v6 row_newbcast:0 row_mask:0xf bank_mask:0xf
L_hop3188:
  s_cbranch_execz L_hop3214
  v_and_b32_dpp v15, v64, v7 row_newbcast:0 row_mask:0xf bank_mask:0xf
  v_and_b32_dpp v16, v64, v4 row_newbcast:8 row_mask:0xf bank_mask:0xf
  v_and_b32_dpp v17, v64, v5 row_newbcast:8 row_mask:0xf bank_mask:0xf
  v_and_b32_dpp v18, v64, v6 row_newbcast:8 row_mask:0xf bank_mask:0xf
  v_and_b32_dpp v19, v64, v7 row_newbcast:8 row_mask:0xf bank_mask:0xf
  v_mfma_f32_16x16x32_bf16 v[20:23], v[12:15], v[144:147], v[20:23]
  v_and_b32_dpp v12, v64, v4 row_newbcast:4 row_mask:0xf bank_mask:0xf
  v_and_b32_dpp v13, v64, v5 row_newbcast:4 row_mask:0xf bank_mask:0xf
  v_and_b32_dpp v14, v64, v6 row_newbcast:4 row_mask:0xf bank_mask:0xf
  v_and_b32_dpp v15, v64, v7 row_newbcast:4 row_mask:0xf bank_mask:0xf
  v_mfma_f32_16x16x32_bf16 v[20:23], v[16:19], v[148:151], v[20:23]
  v_and_b32_dpp v16, v64, v4 row_newbcast:12 row_mask:0xf bank_mask:0xf
  v_and_b32_dpp v17, v64, v5 row_newbcast:12 row_mask:0xf bank_mask:0xf
  v_and_b32_dpp v18, v64, v6 row_newbcast:12 row_mask:0xf bank_mask:0xf
  v_and_b32_dpp v19, v64, v7 row_newbcast:12 row_mask:0xf bank_mask:0xf
  v_mfma_f32_16x16x32_bf16 v[20:23], v[12:15], v[152:155], v[20:23]
L_gl102:
  s_memrealtime s[30:31]
  s_waitcnt lgkmcnt(0)
  s_sub_u32 s29, s30, s28
  s_cmp_lt_u32 s29, 3245
  s_cbranch_scc0 L_gk101
  s_sleep 1
  s_branch L_gl102
L_gk101:
L_hop3214:
  s_cbranch_execz L_hop3226
  buffer_load_dwordx4 v[124:127], v1, s[48:51], s69 offen offset:0 nt
  buffer_load_dwordx4 v[60:63], v1, s[48:51], s69 offen offset:1024 nt
  v_mfma_f32_16x16x32_bf16 v[20:23], v[16:19], v[156:159], v[20:23]
  buffer_load_dwordx4 v[144:147], v1, s[48:51], s69 offen offset:2048 nt
  buffer_load_dwordx4 v[148:151], v1, s[48:51], s69 offen offset:3072 nt
  s_add_u32 s69, s69, 16384
  buffer_load_dwordx4 v[152:155], v3, s[56:59], s71 offen nt
  s_add_u32 s71, s71, 5120
  buffer_load_dwordx4 v[156:159], v3, s[56:59], s71 offen nt
  s_waitcnt vmcnt(20)
  v_and_b32_dpp v12, v65, v4 row_newbcast:0 row_mask:0xf bank_mask:0xf
L_hop3226:
  s_cbranch_execz L_hop3243
  v_and_b32_dpp v13, v65, v5 row_newbcast:0 row_mask:0xf bank_mask:0xf
  v_and_b32_dpp v14, v65, v6 row_newbcast:0 row_mask:0xf bank_mask:0xf
  v_and_b32_dpp v15, v65, v7 row_newbcast:0 row_mask:0xf bank_mask:0xf
  v_and_b32_dpp v16, v65, v4 row_newbcast:8 row_mask:0xf bank_mask:0xf
  v_and_b32_dpp v17, v65, v5 row_newbcast:8 row_mask:0xf bank_mask:0xf
  v_and_b32_dpp v18, v65, v6 row_newbcast:8 row_mask:0xf bank_mask:0xf
  v_and_b32_dpp v19, v65, v7 row_newbcast:8 row_mask:0xf bank_mask:0xf
  v_mfma_f32_16x16x32_bf16 v[20:23], v[12:15], v[176:179], v[20:23]
  v_and_b32_dpp v12, v65, v4 row_newbcast:4 row_mask:0xf bank_mask:0xf
  v_and_b32_dpp v13, v65, v5 row_newbcast:4 row_mask:0xf bank_mask:0xf
  v_and_b32_dpp v14, v65, v6 row_newbcast:4 row_mask:0xf bank_mask:0xf
  v_and_b32_dpp v15, v65, v7 row_newbcast:4 row_mask:0xf bank_mask:0xf
  v_mfma_f32_16x16x32_bf16 v[20:23], v[16:19], v[180:183], v[20:23]
  v_and_b32_dpp v16, v65, v4 row_newbcast:12 row_mask:0xf bank_mask:0xf
  v_and_b32_dpp v17, v65, v5 row_newbcast:12 row_mask:0xf bank_mask:0xf
  v_and_b32_dpp v18, v65, v6 row_newbcast:12 row_mask:0xf bank_mask:0xf
L_hop3243:
  s_cbranch_execz L_hop3265
  v_and_b32_dpp v19, v65, v7 row_newbcast:12 row_mask:0xf bank_mask:0xf
  v_mfma_f32_16x16x32_bf16 v[20:23], v[12:15], v[56:59], v[20:23]
L_gl104:
  s_memrealtime s[30:31]
  s_waitcnt lgkmcnt(0)
  s_sub_u32 s29, s30, s28
  s_cmp_lt_u32 s29, 3302
  s_cbranch_scc0 L_gk103
  s_sleep 1
  s_branch L_gl104
L_gk103:
  buffer_load_dwordx4 v[176:179], v1, s[48:51], s69 offen offset:0 nt
  buffer_load_dwordx4 v[180:183], v1, s[48:51], s69 offen offset:1024 nt
  v_mfma_f32_16x16x32_bf16 v[20:23], v[16:19], v[204:207], v[20:23]
  buffer_load_dwordx4 v[56:59], v1, s[48:51], s69 offen offset:2048 nt
  buffer_load_dwordx4 v[204:207], v1, s[48:51], s69 offen offset:3072 nt
  s_add_u32 s69, s69, 16384
  v_mov_b32 v41, 0
  s_lshl_b32 s77, s3, 2
  v_mov_b32 v45, s77
  ds_read_b32 v44, v41 offset:24
L_hop3265:
  s_cbranch_execz L_hop3282
  ds_read_b32 v34, v45 offset:32
  s_waitcnt vmcnt(18)
  v_and_b32_dpp v12, v66, v4 row_newbcast:0 row_mask:0xf bank_mask:0xf
  v_and_b32_dpp v13, v66, v5 row_newbcast:0 row_mask:0xf bank_mask:0xf
  v_and_b32_dpp v14, v66, v6 row_newbcast:0 row_mask:0xf bank_mask:0xf
  v_and_b32_dpp v15, v66, v7 row_newbcast:0 row_mask:0xf bank_mask:0xf
  v_and_b32_dpp v16, v66, v4 row_newbcast:8 row_mask:0xf bank_mask:0xf
  v_and_b32_dpp v17, v66, v5 row_newbcast:8 row_mask:0xf bank_mask:0xf
  v_and_b32_dpp v18, v66, v6 row_newbcast:8 row_mask:0xf bank_mask:0xf
  v_and_b32_dpp v19, v66, v7 row_newbcast:8 row_mask:0xf bank_mask:0xf
  v_mfma_f32_16x16x32_bf16 v[20:23], v[12:15], v[228:231], v[20:23]
  v_and_b32_dpp v12, v66, v4 row_newbcast:4 row_mask:0xf bank_mask:0xf
  v_and_b32_dpp v13, v66, v5 row_newbcast:4 row_mask:0xf bank_mask:0xf
  v_and_b32_dpp v14, v66, v6 row_newbcast:4 row_mask:0xf bank_mask:0xf
  v_and_b32_dpp v15, v66, v7 row_newbcast:4 row_mask:0xf bank_mask:0xf
  v_mfma_f32_16x16x32_bf16 v[20:23], v[16:19], v[216:219], v[20:23]
L_hop3282:
  s_cbranch_execz L_hop3303
  v_and_b32_dpp v16, v66, v4 row_newbcast:12 row_mask:0xf bank_mask:0xf
  v_and_b32_dpp v17, v66, v5 row_newbcast:12 row_mask:0xf bank_mask:0xf
  v_and_b32_dpp v18, v66, v6 row_newbcast:12 row_mask:0xf bank_mask:0xf
  v_and_b32_dpp v19, v66, v7 row_newbcast:12 row_mask:0xf bank_mask:0xf
  v_mfma_f32_16x16x32_bf16 v[20:23], v[12:15], v[188:191], v[20:23]
L_gl106:
  s_memrealtime s[30:31]
  s_waitcnt lgkmcnt(0)
  s_sub_u32 s29, s30, s28
  s_cmp_lt_u32 s29, 3359
  s_cbranch_scc0 L_gk105
  s_sleep 1
  s_branch L_gl106
L_gk105:
  buffer_load_dwordx4 v[228:231], v1, s[48:51], s69 offen offset:0 nt
  buffer_load_dwordx4 v[216:219], v1, s[48:51], s69 offen offset:1024 nt
  v_mfma_f32_16x16x32_bf16 v[20:23], v[16:19], v[184:187], v[20:23]
  buffer_load_dwordx4 v[188:191], v1, s[48:51], s69 offen offset:2048 nt
  buffer_load_dwordx4 v[184:187], v1, s[48:51], s69 offen offset:3072 nt
  s_add_u32 s69, s69, 16384
L_hop3303:
  s_cbranch_execz L_hop3332
  s_waitcnt lgkmcnt(0)
  v_cmp_ne_u32 vcc, 0, v44
  s_cbranch_vccnz L_fok107
  v_mov_b32 v41, 0
  s_mov_b32 s97, 0
  s_nop 9
L_sp109:
  ds_read_b32 v44, v41 offset:24
  s_add_u32 s97, s97, 1
  s_waitcnt lgkmcnt(0)
  v_cmp_le_u32 vcc, 1, v44
  s_cbranch_vccnz L_ok108
  s_cmp_gt_u32 s97, 4000000
  s_cbranch_scc1 L_ok108
  s_sleep 1
  s_branch L_sp109
  s_nop 9
L_ok108:
  s_lshl_b32 s77, s3, 2
  v_mov_b32 v41, s77
  ds_read_b32 v34, v41 offset:32
  s_waitcnt lgkmcnt(0)
L_fok107:
  s_waitcnt vmcnt(16)
  v_and_b32_dpp v12, v67, v4 row_newbcast:0 row_mask:0xf bank_mask:0xf
  v_and_b32_dpp v13, v67, v5 row_newbcast:0 row_mask:0xf bank_mask:0xf
  v_and_b32_dpp v14, v67, v6 row_newbcast:0 row_mask:0xf bank_mask:0xf
  v_and_b32_dpp v15, v67, v7 row_newbcast:0 row_mask:0xf bank_mask:0xf
L_hop3332:
  s_cbranch_execz L_hop3357
  v_and_b32_dpp v16, v67, v4 row_newbcast:8 row_mask:0xf bank_mask:0xf
  v_and_b32_dpp v17, v67, v5 row_newbcast:8 row_mask:0xf bank_mask:0xf
  v_and_b32_dpp v18, v67, v6 row_newbcast:8 row_mask:0xf bank_mask:0xf
  v_and_b32_dpp v19, v67, v7 row_newbcast:8 row_mask:0xf bank_mask:0xf
  v_mfma_f32_16x16x32_bf16 v[20:23], v[12:15], v[80:83], v[20:23]
  v_and_b32_dpp v12, v67, v4 row_newbcast:4 row_mask:0xf bank_mask:0xf
  v_and_b32_dpp v13, v67, v5 row_newbcast:4 row_mask:0xf bank_mask:0xf
  v_and_b32_dpp v14, v67, v6 row_newbcast:4 row_mask:0xf bank_mask:0xf
  v_and_b32_dpp v15, v67, v7 row_newbcast:4 row_mask:0xf bank_mask:0xf
  v_mfma_f32_16x16x32_bf16 v[20:23], v[16:19], v[84:87], v[20:23]
  v_and_b32_dpp v16, v67, v4 row_newbcast:12 row_mask:0xf bank_mask:0xf
  v_and_b32_dpp v17, v67, v5 row_newbcast:12 row_mask:0xf bank_mask:0xf
  v_and_b32_dpp v18, v67, v6 row_newbcast:12 row_mask:0xf bank_mask:0xf
  v_and_b32_dpp v19, v67, v7 row_newbcast:12 row_mask:0xf bank_mask:0xf
  v_mfma_f32_16x16x32_bf16 v[20:23], v[12:15], v[52:55], v[20:23]
L_gl111:
  s_memrealtime s[30:31]
  s_waitcnt lgkmcnt(0)
  s_sub_u32 s29, s30, s28
  s_cmp_lt_u32 s29, 3416
  s_cbranch_scc0 L_gk110
  s_sleep 1
  s_branch L_gl111
L_gk110:
L_hop3357:
  s_cbranch_execz L_hop3370
  buffer_load_dwordx4 v[80:83], v1, s[48:51], s69 offen offset:0 nt
  buffer_load_dwordx4 v[84:87], v1, s[48:51], s69 offen offset:1024 nt
  v_mfma_f32_16x16x32_bf16 v[20:23], v[16:19], v[104:107], v[20:23]
  buffer_load_dwordx4 v[52:55], v1, s[48:51], s69 offen offset:2048 nt
  buffer_load_dwordx4 v[104:107], v1, s[48:51], s69 offen offset:3072 nt
  s_add_u32 s69, s69, 16384
  s_waitcnt vmcnt(14)
  v_and_b32_dpp v12, v68, v4 row_newbcast:0 row_mask:0xf bank_mask:0xf
  v_and_b32_dpp v13, v68, v5 row_newbcast:0 row_mask:0xf bank_mask:0xf
  v_and_b32_dpp v14, v68, v6 row_newbcast:0 row_mask:0xf bank_mask:0xf
  v_and_b32_dpp v15, v68, v7 row_newbcast:0 row_mask:0xf bank_mask:0xf
  v_and_b32_dpp v16, v68, v4 row_newbcast:8 row_mask:0xf bank_mask:0xf
L_hop3370:
  s_cbranch_execz L_hop3394
  v_and_b32_dpp v17, v68, v5 row_newbcast:8 row_mask:0xf bank_mask:0xf
  v_and_b32_dpp v18, v68, v6 row_newbcast:8 row_mask:0xf bank_mask:0xf
  v_and_b32_dpp v19, v68, v7 row_newbcast:8 row_mask:0xf bank_mask:0xf
  v_mfma_f32_16x16x32_bf16 v[20:23], v[12:15], v[124:127], v[20:23]
  v_and_b32_dpp v12, v68, v4 row_newbcast:4 row_mask:0xf bank_mask:0xf
  v_and_b32_dpp v13, v68, v5 row_newbcast:4 row_mask:0xf bank_mask:0xf
  v_and_b32_dpp v14, v68, v6 row_newbcast:4 row_mask:0xf bank_mask:0xf
  v_and_b32_dpp v15, v68, v7 row_newbcast:4 row_mask:0xf bank_mask:0xf
  v_mfma_f32_16x16x32_bf16 v[20:23], v[16:19], v[60:63], v[20:23]
  v_and_b32_dpp v16, v68, v4 row_newbcast:12 row_mask:0xf bank_mask:0xf
  v_and_b32_dpp v17, v68, v5 row_newbcast:12 row_mask:0xf bank_mask:0xf
  v_and_b32_dpp v18, v68, v6 row_newbcast:12 row_mask:0xf bank_mask:0xf
  v_and_b32_dpp v19, v68, v7 row_newbcast:12 row_mask:0xf bank_mask:0xf
  v_mfma_f32_16x16x32_bf16 v[20:23], v[12:15], v[144:147], v[20:23]
L_gl113:
  s_memrealtime s[30:31]
  s_waitcnt lgkmcnt(0)
  s_sub_u32 s29, s30, s28
  s_cmp_lt_u32 s29, 3473
  s_cbranch_scc0 L_gk112
  s_sleep 1
  s_branch L_gl113
L_gk112:
L_hop3394:
  s_cbranch_execz L_hop3408
  buffer_load_dwordx4 v[64:67], v1, s[48:51], s69 offen offset:0 nt
  buffer_load_dwordx4 v[124:127], v1, s[48:51], s69 offen offset:1024 nt
  v_mfma_f32_16x16x32_bf16 v[20:23], v[16:19], v[148:151], v[20:23]
  buffer_load_dwordx4 v[60:63], v1, s[48:51], s69 offen offset:2048 nt
  buffer_load_dwordx4 v[144:147], v1, s[48:51], s69 offen offset:3072 nt
  s_add_u32 s69, s69, 16384
  s_waitcnt vmcnt(12)
  v_and_b32_dpp v12, v69, v4 row_newbcast:0 row_mask:0xf bank_mask:0xf
  v_and_b32_dpp v13, v69, v5 row_newbcast:0 row_mask:0xf bank_mask:0xf
  v_and_b32_dpp v14, v69, v6 row_newbcast:0 row_mask:0xf bank_mask:0xf
  v_and_b32_dpp v15, v69, v7 row_newbcast:0 row_mask:0xf bank_mask:0xf
  v_and_b32_dpp v16, v69, v4 row_newbcast:8 row_mask:0xf bank_mask:0xf
  v_and_b32_dpp v17, v69, v5 row_newbcast:8 row_mask:0xf bank_mask:0xf
L_hop3408:
  s_cbranch_execz L_hop3431
  v_and_b32_dpp v18, v69, v6 row_newbcast:8 row_mask:0xf bank_mask:0xf
  v_and_b32_dpp v19, v69, v7 row_newbcast:8 row_mask:0xf bank_mask:0xf
  v_mfma_f32_16x16x32_bf16 v[20:23], v[12:15], v[176:179], v[20:23]
  v_and_b32_dpp v12, v69, v4 row_newbcast:4 row_mask:0xf bank_mask:0xf
  v_and_b32_dpp v13, v69, v5 row_newbcast:4 row_mask:0xf bank_mask:0xf
  v_and_b32_dpp v14, v69, v6 row_newbcast:4 row_mask:0xf bank_mask:0xf
  v_and_b32_dpp v15, v69, v7 row_newbcast:4 row_mask:0xf bank_mask:0xf
  v_mfma_f32_16x16x32_bf16 v[20:23], v[16:19], v[180:183], v[20:23]
  v_and_b32_dpp v16, v69, v4 row_newbcast:12 row_mask:0xf bank_mask:0xf
  v_and_b32_dpp v17, v69, v5 row_newbcast:12 row_mask:0xf bank_mask:0xf
  v_and_b32_dpp v18, v69, v6 row_newbcast:12 row_mask:0xf bank_mask:0xf
  v_and_b32_dpp v19, v69, v7 row_newbcast:12 row_mask:0xf bank_mask:0xf
  v_mfma_f32_16x16x32_bf16 v[20:23], v[12:15], v[56:59], v[20:23]
L_gl115:
  s_memrealtime s[30:31]
  s_waitcnt lgkmcnt(0)
  s_sub_u32 s29, s30, s28
  s_cmp_lt_u32 s29, 3530
  s_cbranch_scc0 L_gk114
  s_sleep 1
  s_branch L_gl115
L_gk114:
L_hop3431:
  s_cbranch_execz L_hop3446
  buffer_load_dwordx4 v[148:151], v1, s[48:51], s69 offen offset:0 nt
  buffer_load_dwordx4 v[176:179], v1, s[48:51], s69 offen offset:1024 nt
  v_mfma_f32_16x16x32_bf16 v[20:23], v[16:19], v[204:207], v[20:23]
  buffer_load_dwordx4 v[180:183], v1, s[48:51], s69 offen offset:2048 nt
  buffer_load_dwordx4 v[56:59], v1, s[48:51], s69 offen offset:3072 nt
  s_add_u32 s69, s69, 16384
  s_waitcnt vmcnt(12)
  v_and_b32_dpp v12, v70, v4 row_newbcast:0 row_mask:0xf bank_mask:0xf
  v_and_b32_dpp v13, v70, v5 row_newbcast:0 row_mask:0xf bank_mask:0xf
  v_and_b32_dpp v14, v70, v6 row_newbcast:0 row_mask:0xf bank_mask:0xf
  v_and_b32_dpp v15, v70, v7 row_newbcast:0 row_mask:0xf bank_mask:0xf
  v_and_b32_dpp v16, v70, v4 row_newbcast:8 row_mask:0xf bank_mask:0xf
  v_and_b32_dpp v17, v70, v5 row_newbcast:8 row_mask:0xf bank_mask:0xf
  v_and_b32_dpp v18, v70, v6 row_newbcast:8 row_mask:0xf bank_mask:0xf
L_hop3446:
  s_cbranch_execz L_hop3468
  v_and_b32_dpp v19, v70, v7 row_newbcast:8 row_mask:0xf bank_mask:0xf
  v_mfma_f32_16x16x32_bf16 v[20:23], v[12:15], v[228:231], v[20:23]
  v_and_b32_dpp v12, v70, v4 row_newbcast:4 row_mask:0xf bank_mask:0xf
  v_and_b32_dpp v13, v70, v5 row_newbcast:4 row_mask:0xf bank_mask:0xf
  v_and_b32_dpp v14, v70, v6 row_newbcast:4 row_mask:0xf bank_mask:0xf
  v_and_b32_dpp v15, v70, v7 row_newbcast:4 row_mask:0xf bank_mask:0xf
  v_mfma_f32_16x16x32_bf16 v[20:23], v[16:19], v[216:219], v[20:23]
  v_and_b32_dpp v16, v70, v4 row_newbcast:12 row_mask:0xf bank_mask:0xf
  v_and_b32_dpp v17, v70, v5 row_newbcast:12 row_mask:0xf bank_mask:0xf
  v_and_b32_dpp v18, v70, v6 row_newbcast:12 row_mask:0xf bank_mask:0xf
  v_and_b32_dpp v19, v70, v7 row_newbcast:12 row_mask:0xf bank_mask:0xf
  v_mfma_f32_16x16x32_bf16 v[20:23], v[12:15], v[188:191], v[20:23]
L_gl117:
  s_memrealtime s[30:31]
  s_waitcnt lgkmcnt(0)
  s_sub_u32 s29, s30, s28
  s_cmp_lt_u32 s29, 3587
  s_cbranch_scc0 L_gk116
  s_sleep 1
  s_branch L_gl117
L_gk116:
L_hop3468:
  s_cbranch_execz L_hop3484
  buffer_load_dwordx4 v[204:207], v1, s[48:51], s69 offen offset:0 nt
  buffer_load_dwordx4 v[228:231], v1, s[48:51], s69 offen offset:1024 nt
  v_mfma_f32_16x16x32_bf16 v[20:23], v[16:19], v[184:187], v[20:23]
  buffer_load_dwordx4 v[216:219], v1, s[48:51], s69 offen offset:2048 nt
  buffer_load_dwordx4 v[188:191], v1, s[48:51], s69 offen offset:3072 nt
  s_add_u32 s69, s69, 16384
  s_waitcnt vmcnt(12)
  v_and_b32_dpp v12, v71, v4 row_newbcast:0 row_mask:0xf bank_mask:0xf
  v_and_b32_dpp v13, v71, v5 row_newbcast:0 row_mask:0xf bank_mask:0xf
  v_and_b32_dpp v14, v71, v6 row_newbcast:0 row_mask:0xf bank_mask:0xf
  v_and_b32_dpp v15, v71, v7 row_newbcast:0 row_mask:0xf bank_mask:0xf
  v_and_b32_dpp v16, v71, v4 row_newbcast:8 row_mask:0xf bank_mask:0xf
  v_and_b32_dpp v17, v71, v5 row_newbcast:8 row_mask:0xf bank_mask:0xf
  v_and_b32_dpp v18, v71, v6 row_newbcast:8 row_mask:0xf bank_mask:0xf
  v_and_b32_dpp v19, v71, v7 row_newbcast:8 row_mask:0xf bank_mask:0xf
L_hop3484:
  s_cbranch_execz L_hop3505
  v_mfma_f32_16x16x32_bf16 v[20:23], v[12:15], v[80:83], v[20:23]
  v_and_b32_dpp v12, v71, v4 row_newbcast:4 row_mask:0xf bank_mask:0xf
  v_and_b32_dpp v13, v71, v5 row_newbcast:4 row_mask:0xf bank_mask:0xf
  v_and_b32_dpp v14, v71, v6 row_newbcast:4 row_mask:0xf bank_mask:0xf
  v_and_b32_dpp v15, v71, v7 row_newbcast:4 row_mask:0xf bank_mask:0xf
  v_mfma_f32_16x16x32_bf16 v[20:23], v[16:19], v[84:87], v[20:23]
  v_and_b32_dpp v16, v71, v4 row_newbcast:12 row_mask:0xf bank_mask:0xf
  v_and_b32_dpp v17, v71, v5 row_newbcast:12 row_mask:0xf bank_mask:0xf
  v_and_b32_dpp v18, v71, v6 row_newbcast:12 row_mask:0xf bank_mask:0xf
  v_and_b32_dpp v19, v71, v7 row_newbcast:12 row_mask:0xf bank_mask:0xf
  v_mfma_f32_16x16x32_bf16 v[20:23], v[12:15], v[52:55], v[20:23]
L_gl119:
  s_memrealtime s[30:31]
  s_waitcnt lgkmcnt(0)
  s_sub_u32 s29, s30, s28
  s_cmp_lt_u32 s29, 3644
  s_cbranch_scc0 L_gk118
  s_sleep 1
  s_branch L_gl119
L_gk118:
L_hop3505:
  s_cbranch_execz L_hop3522
  buffer_load_dwordx4 v[184:187], v1, s[48:51], s69 offen offset:0 nt
  buffer_load_dwordx4 v[80:83], v1, s[48:51], s69 offen offset:1024 nt
  v_mfma_f32_16x16x32_bf16 v[20:23], v[16:19], v[104:107], v[20:23]
  buffer_load_dwordx4 v[84:87], v1, s[48:51], s69 offen offset:2048 nt
  buffer_load_dwordx4 v[52:55], v1, s[48:51], s69 offen offset:3072 nt
  s_add_u32 s69, s69, 16384
  s_waitcnt vmcnt(12)
  v_and_b32_dpp v12, v72, v4 row_newbcast:0 row_mask:0xf bank_mask:0xf
  v_and_b32_dpp v13, v72, v5 row_newbcast:0 row_mask:0xf bank_mask:0xf
  v_and_b32_dpp v14, v72, v6 row_newbcast:0 row_mask:0xf bank_mask:0xf
  v_and_b32_dpp v15, v72, v7 row_newbcast:0 row_mask:0xf bank_mask:0xf
  v_and_b32_dpp v16, v72, v4 row_newbcast:8 row_mask:0xf bank_mask:0xf
  v_and_b32_dpp v17, v72, v5 row_newbcast:8 row_mask:0xf bank_mask:0xf
  v_and_b32_dpp v18, v72, v6 row_newbcast:8 row_mask:0xf bank_mask:0xf
  v_and_b32_dpp v19, v72, v7 row_newbcast:8 row_mask:0xf bank_mask:0xf
  v_mfma_f32_16x16x32_bf16 v[20:23], v[12:15], v[64:67], v[20:23]
L_hop3522:
  s_cbranch_execz L_hop3543
  v_and_b32_dpp v12, v72, v4 row_newbcast:4 row_mask:0xf bank_mask:0xf
  v_and_b32_dpp v13, v72, v5 row_newbcast:4 row_mask:0xf bank_mask:0xf
  v_and_b32_dpp v14, v72, v6 row_newbcast:4 row_mask:0xf bank_mask:0xf
  v_and_b32_dpp v15, v72, v7 row_newbcast:4 row_mask:0xf bank_mask:0xf
  v_mfma_f32_16x16x32_bf16 v[20:23], v[16:19], v[124:127], v[20:23]
  v_and_b32_dpp v16, v72, v4 row_newbcast:12 row_mask:0xf bank_mask:0xf
  v_and_b32_dpp v17, v72, v5 row_newbcast:12 row_mask:0xf bank_mask:0xf
  v_and_b32_dpp v18, v72, v6 row_newbcast:12 row_mask:0xf bank_mask:0xf
  v_and_b32_dpp v19, v72, v7 row_newbcast:12 row_mask:0xf bank_mask:0xf
  v_mfma_f32_16x16x32_bf16 v[20:23], v[12:15], v[60:63], v[20:23]
L_gl121:
  s_memrealtime s[30:31]
  s_waitcnt lgkmcnt(0)
  s_sub_u32 s29, s30, s28
  s_cmp_lt_u32 s29, 3701
  s_cbranch_scc0 L_gk120
  s_sleep 1
  s_branch L_gl121
L_gk120:
  buffer_load_dwordx4 v[104:107], v1, s[48:51], s69 offen offset:0 nt
L_hop3543:
  s_cbranch_execz L_hop3560
  buffer_load_dwordx4 v[68:71], v1, s[48:51], s69 offen offset:1024 nt
  v_mfma_f32_16x16x32_bf16 v[20:23], v[16:19], v[144:147], v[20:23]
  buffer_load_dwordx4 v[64:67], v1, s[48:51], s69 offen offset:2048 nt
  buffer_load_dwordx4 v[124:127], v1, s[48:51], s69 offen offset:3072 nt
  s_add_u32 s69, s69, 16384
  s_waitcnt vmcnt(12)
  v_and_b32_dpp v12, v73, v4 row_newbcast:0 row_mask:0xf bank_mask:0xf
  v_and_b32_dpp v13, v73, v5 row_newbcast:0 row_mask:0xf bank_mask:0xf
  v_and_b32_dpp v14, v73, v6 row_newbcast:0 row_mask:0xf bank_mask:0xf
  v_and_b32_dpp v15, v73, v7 row_newbcast:0 row_mask:0xf bank_mask:0xf
  v_and_b32_dpp v16, v73, v4 row_newbcast:8 row_mask:0xf bank_mask:0xf
  v_and_b32_dpp v17, v73, v5 row_newbcast:8 row_mask:0xf bank_mask:0xf
  v_and_b32_dpp v18, v73, v6 row_newbcast:8 row_mask:0xf bank_mask:0xf
  v_and_b32_dpp v19, v73, v7 row_newbcast:8 row_mask:0xf bank_mask:0xf
  v_mfma_f32_16x16x32_bf16 v[20:23], v[12:15], v[148:151], v[20:23]
  v_and_b32_dpp v12, v73, v4 row_newbcast:4 row_mask:0xf bank_mask:0xf
L_hop3560:
  s_cbranch_execz L_hop3581
  v_and_b32_dpp v13, v73, v5 row_newbcast:4 row_mask:0xf bank_mask:0xf
  v_and_b32_dpp v14, v73, v6 row_newbcast:4 row_mask:0xf bank_mask:0xf
  v_and_b32_dpp v15, v73, v7 row_newbcast:4 row_mask:0xf bank_mask:0xf
  v_mfma_f32_16x16x32_bf16 v[20:23], v[16:19], v[176:179], v[20:23]
  v_and_b32_dpp v16, v73, v4 row_newbcast:12 row_mask:0xf bank_mask:0xf
  v_and_b32_dpp v17, v73, v5 row_newbcast:12 row_mask:0xf bank_mask:0xf
  v_and_b32_dpp v18, v73, v6 row_newbcast:12 row_mask:0xf bank_mask:0xf
  v_and_b32_dpp v19, v73, v7 row_newbcast:12 row_mask:0xf bank_mask:0xf
  v_mfma_f32_16x16x32_bf16 v[20:23], v[12:15], v[180:183], v[20:23]
L_gl123:
  s_memrealtime s[30:31]
  s_waitcnt lgkmcnt(0)
  s_sub_u32 s29, s30, s28
  s_cmp_lt_u32 s29, 3758
  s_cbranch_scc0 L_gk122
  s_sleep 1
  s_branch L_gl123
L_gk122:
  buffer_load_dwordx4 v[60:63], v1, s[48:51], s69 offen offset:0 nt
  buffer_load_dwordx4 v[144:147], v1, s[48:51], s69 offen offset:1024 nt
L_hop3581:
  s_cbranch_execz L_hop3598
  v_mfma_f32_16x16x32_bf16 v[20:23], v[16:19], v[56:59], v[20:23]
  buffer_load_dwordx4 v[148:151], v1, s[48:51], s69 offen offset:2048 nt
  buffer_load_dwordx4 v[176:179], v1, s[48:51], s69 offen offset:3072 nt
  s_add_u32 s69, s69, 16384
  s_waitcnt vmcnt(12)
  v_and_b32_dpp v12, v74, v4 row_newbcast:0 row_mask:0xf bank_mask:0xf
  v_and_b32_dpp v13, v74, v5 row_newbcast:0 row_mask:0xf bank_mask:0xf
  v_and_b32_dpp v14, v74, v6 row_newbcast:0 row_mask:0xf bank_mask:0xf
  v_and_b32_dpp v15, v74, v7 row_newbcast:0 row_mask:0xf bank_mask:0xf
  v_and_b32_dpp v16, v74, v4 row_newbcast:8 row_mask:0xf bank_mask:0xf
  v_and_b32_dpp v17, v74, v5 row_newbcast:8 row_mask:0xf bank_mask:0xf
  v_and_b32_dpp v18, v74, v6 row_newbcast:8 row_mask:0xf bank_mask:0xf
  v_and_b32_dpp v19, v74, v7 row_newbcast:8 row_mask:0xf bank_mask:0xf
  v_mfma_f32_16x16x32_bf16 v[20:23], v[12:15], v[204:207], v[20:23]
  v_and_b32_dpp v12, v74, v4 row_newbcast:4 row_mask:0xf bank_mask:0xf
  v_and_b32_dpp v13, v74, v5 row_newbcast:4 row_mask:0xf bank_mask:0xf
L_hop3598:
  s_cbranch_execz L_hop3619
  v_and_b32_dpp v14, v74, v6 row_newbcast:4 row_mask:0xf bank_mask:0xf
  v_and_b32_dpp v15, v74, v7 row_newbcast:4 row_mask:0xf bank_mask:0xf
  v_mfma_f32_16x16x32_bf16 v[20:23], v[16:19], v[228:231], v[20:23]
  v_and_b32_dpp v16, v74, v4 row_newbcast:12 row_mask:0xf bank_mask:0xf
  v_and_b32_dpp v17, v74, v5 row_newbcast:12 row_mask:0xf bank_mask:0xf
  v_and_b32_dpp v18, v74, v6 row_newbcast:12 row_mask:0xf bank_mask:0xf
  v_and_b32_dpp v19, v74, v7 row_newbcast:12 row_mask:0xf bank_mask:0xf
  v_mfma_f32_16x16x32_bf16 v[20:23], v[12:15], v[216:219], v[20:23]
L_gl125:
  s_memrealtime s[30:31]
  s_waitcnt lgkmcnt(0)
  s_sub_u32 s29, s30, s28
  s_cmp_lt_u32 s29, 3815
  s_cbranch_scc0 L_gk124
  s_sleep 1
  s_branch L_gl125
L_gk124:
  buffer_load_dwordx4 v[180:183], v1, s[48:51], s69 offen offset:0 nt
  buffer_load_dwordx4 v[56:59], v1, s[48:51], s69 offen offset:1024 nt
  v_mfma_f32_16x16x32_bf16 v[20:23], v[16:19], v[188:191], v[20:23]
L_hop3619:
  s_cbranch_execz L_hop3636
  buffer_load_dwordx4 v[204:207], v1, s[48:51], s69 offen offset:2048 nt
  buffer_load_dwordx4 v[228:231], v1, s[48:51], s69 offen offset:3072 nt
  s_add_u32 s69, s69, 16384
  s_waitcnt vmcnt(12)
  v_and_b32_dpp v12, v75, v4 row_newbcast:0 row_mask:0xf bank_mask:0xf
  v_and_b32_dpp v13, v75, v5 row_newbcast:0 row_mask:0xf bank_mask:0xf
  v_and_b32_dpp v14, v75, v6 row_newbcast:0 row_mask:0xf bank_mask:0xf
  v_and_b32_dpp v15, v75, v7 row_newbcast:0 row_mask:0xf bank_mask:0xf
  v_and_b32_dpp v16, v75, v4 row_newbcast:8 row_mask:0xf bank_mask:0xf
  v_and_b32_dpp v17, v75, v5 row_newbcast:8 row_mask:0xf bank_mask:0xf
  v_and_b32_dpp v18, v75, v6 row_newbcast:8 row_mask:0xf bank_mask:0xf
  v_and_b32_dpp v19, v75, v7 row_newbcast:8 row_mask:0xf bank_mask:0xf
  v_mfma_f32_16x16x32_bf16 v[20:23], v[12:15], v[184:187], v[20:23]
  v_and_b32_dpp v12, v75, v4 row_newbcast:4 row_mask:0xf bank_mask:0xf
  v_and_b32_dpp v13, v75, v5 row_newbcast:4 row_mask:0xf bank_mask:0xf
  v_and_b32_dpp v14, v75, v6 row_newbcast:4 row_mask:0xf bank_mask:0xf
L_hop3636:
  s_cbranch_execz L_hop3657
  v_and_b32_dpp v15, v75, v7 row_newbcast:4 row_mask:0xf bank_mask:0xf
  v_mfma_f32_16x16x32_bf16 v[20:23], v[16:19], v[80:83], v[20:23]
  v_and_b32_dpp v16, v75, v4 row_newbcast:12 row_mask:0xf bank_mask:0xf
  v_and_b32_dpp v17, v75, v5 row_newbcast:12 row_mask:0xf bank_mask:0xf
  v_and_b32_dpp v18, v75, v6 row_newbcast:12 row_mask:0xf bank_mask:0xf
  v_and_b32_dpp v19, v75, v7 row_newbcast:12 row_mask:0xf bank_mask:0xf
  v_mfma_f32_16x16x32_bf16 v[20:23], v[12:15], v[84:87], v[20:23]
L_gl127:
  s_memrealtime s[30:31]
  s_waitcnt lgkmcnt(0)
  s_sub_u32 s29, s30, s28
  s_cmp_lt_u32 s29, 3872
  s_cbranch_scc0 L_gk126
  s_sleep 1
  s_branch L_gl127
L_gk126:
  buffer_load_dwordx4 v[216:219], v1, s[48:51], s69 offen offset:0 nt
  buffer_load_dwordx4 v[188:191], v1, s[48:51], s69 offen offset:1024 nt
  v_mfma_f32_16x16x32_bf16 v[20:23], v[16:19], v[52:55], v[20:23]
  buffer_load_dwordx4 v[184:187], v1, s[48:51], s69 offen offset:2048 nt
L_hop3657:
  s_cbranch_execz L_hop3674
  buffer_load_dwordx4 v[80:83], v1, s[48:51], s69 offen offset:3072 nt
  s_waitcnt vmcnt(12)
  v_and_b32_dpp v12, v76, v4 row_newbcast:0 row_mask:0xf bank_mask:0xf
  v_and_b32_dpp v13, v76, v5 row_newbcast:0 row_mask:0xf bank_mask:0xf
  v_and_b32_dpp v14, v76, v6 row_newbcast:0 row_mask:0xf bank_mask:0xf
  v_and_b32_dpp v15, v76, v7 row_newbcast:0 row_mask:0xf bank_mask:0xf
  v_and_b32_dpp v16, v76, v4 row_newbcast:8 row_mask:0xf bank_mask:0xf
  v_and_b32_dpp v17, v76, v5 row_newbcast:8 row_mask:0xf bank_mask:0xf
  v_and_b32_dpp v18, v76, v6 row_newbcast:8 row_mask:0xf bank_mask:0xf
  v_and_b32_dpp v19, v76, v7 row_newbcast:8 row_mask:0xf bank_mask:0xf
  v_mfma_f32_16x16x32_bf16 v[20:23], v[12:15], v[104:107], v[20:23]
  v_and_b32_dpp v12, v76, v4 row_newbcast:4 row_mask:0xf bank_mask:0xf
  v_and_b32_dpp v13, v76, v5 row_newbcast:4 row_mask:0xf bank_mask:0xf
  v_and_b32_dpp v14, v76, v6 row_newbcast:4 row_mask:0xf bank_mask:0xf
  v_and_b32_dpp v15, v76, v7 row_newbcast:4 row_mask:0xf bank_mask:0xf
  v_mfma_f32_16x16x32_bf16 v[20:23], v[16:19], v[68:71], v[20:23]
L_hop3674:
  s_cbranch_execz L_hop3691
  v_and_b32_dpp v16, v76, v4 row_newbcast:12 row_mask:0xf bank_mask:0xf
  v_and_b32_dpp v17, v76, v5 row_newbcast:12 row_mask:0xf bank_mask:0xf
  v_and_b32_dpp v18, v76, v6 row_newbcast:12 row_mask:0xf bank_mask:0xf
  v_and_b32_dpp v19, v76, v7 row_newbcast:12 row_mask:0xf bank_mask:0xf
  v_mfma_f32_16x16x32_bf16 v[20:23], v[12:15], v[64:67], v[20:23]
  s_nop 0
  v_mfma_f32_16x16x32_bf16 v[20:23], v[16:19], v[124:127], v[20:23]
  s_waitcnt vmcnt(8)
  v_and_b32_dpp v12, v77, v4 row_newbcast:0 row_mask:0xf bank_mask:0xf
  v_and_b32_dpp v13, v77, v5 row_newbcast:0 row_mask:0xf bank_mask:0xf
  v_and_b32_dpp v14, v77, v6 row_newbcast:0 row_mask:0xf bank_mask:0xf
  v_and_b32_dpp v15, v77, v7 row_newbcast:0 row_mask:0xf bank_mask:0xf
  v_and_b32_dpp v16, v77, v4 row_newbcast:8 row_mask:0xf bank_mask:0xf
  v_and_b32_dpp v17, v77, v5 row_newbcast:8 row_mask:0xf bank_mask:0xf
  v_and_b32_dpp v18, v77, v6 row_newbcast:8 row_mask:0xf bank_mask:0xf
  v_and_b32_dpp v19, v77, v7 row_newbcast:8 row_mask:0xf bank_mask:0xf
L_hop3691:
  s_cbranch_execz L_hop3709
  v_mfma_f32_16x16x32_bf16 v[20:23], v[12:15], v[60:63], v[20:23]
  v_and_b32_dpp v12, v77, v4 row_newbcast:4 row_mask:0xf bank_mask:0xf
  v_and_b32_dpp v13, v77, v5 row_newbcast:4 row_mask:0xf bank_mask:0xf
  v_and_b32_dpp v14, v77, v6 row_newbcast:4 row_mask:0xf bank_mask:0xf
  v_and_b32_dpp v15, v77, v7 row_newbcast:4 row_mask:0xf bank_mask:0xf
  v_mfma_f32_16x16x32_bf16 v[20:23], v[16:19], v[144:147], v[20:23]
  v_and_b32_dpp v16, v77, v4 row_newbcast:12 row_mask:0xf bank_mask:0xf
  v_and_b32_dpp v17, v77, v5 row_newbcast:12 row_mask:0xf bank_mask:0xf
  v_and_b32_dpp v18, v77, v6 row_newbcast:12 row_mask:0xf bank_mask:0xf
  v_and_b32_dpp v19, v77, v7 row_newbcast:12 row_mask:0xf bank_mask:0xf
  v_mfma_f32_16x16x32_bf16 v[20:23], v[12:15], v[148:151], v[20:23]
  s_nop 0
  v_mfma_f32_16x16x32_bf16 v[20:23], v[16:19], v[176:179], v[20:23]
  s_waitcnt vmcnt(4)
  v_and_b32_dpp v12, v78, v4 row_newbcast:0 row_mask:0xf bank_mask:0xf
  v_and_b32_dpp v13, v78, v5 row_newbcast:0 row_mask:0xf bank_mask:0xf
  v_and_b32_dpp v14, v78, v6 row_newbcast:0 row_mask:0xf bank_mask:0xf
L_hop3709:
  s_cbranch_execz L_hop3725
  v_and_b32_dpp v15, v78, v7 row_newbcast:0 row_mask:0xf bank_mask:0xf
  v_and_b32_dpp v16, v78, v4 row_newbcast:8 row_mask:0xf bank_mask:0xf
  v_and_b32_dpp v17, v78, v5 row_newbcast:8 row_mask:0xf bank_mask:0xf
  v_and_b32_dpp v18, v78, v6 row_newbcast:8 row_mask:0xf bank_mask:0xf
  v_and_b32_dpp v19, v78, v7 row_newbcast:8 row_mask:0xf bank_mask:0xf
  v_mfma_f32_16x16x32_bf16 v[20:23], v[12:15], v[180:183], v[20:23]
  v_and_b32_dpp v12, v78, v4 row_newbcast:4 row_mask:0xf bank_mask:0xf
  v_and_b32_dpp v13, v78, v5 row_newbcast:4 row_mask:0xf bank_mask:0xf
  v_and_b32_dpp v14, v78, v6 row_newbcast:4 row_mask:0xf bank_mask:0xf
  v_and_b32_dpp v15, v78, v7 row_newbcast:4 row_mask:0xf bank_mask:0xf
  v_mfma_f32_16x16x32_bf16 v[20:23], v[16:19], v[56:59], v[20:23]
  v_and_b32_dpp v16, v78, v4 row_newbcast:12 row_mask:0xf bank_mask:0xf
  v_and_b32_dpp v17, v78, v5 row_newbcast:12 row_mask:0xf bank_mask:0xf
  v_and_b32_dpp v18, v78, v6 row_newbcast:12 row_mask:0xf bank_mask:0xf
  v_and_b32_dpp v19, v78, v7 row_newbcast:12 row_mask:0xf bank_mask:0xf
L_hop3725:
  s_cbranch_execz L_hop3743
  v_mfma_f32_16x16x32_bf16 v[20:23], v[12:15], v[204:207], v[20:23]
  s_nop 0
  v_mfma_f32_16x16x32_bf16 v[20:23], v[16:19], v[228:231], v[20:23]
  s_waitcnt vmcnt(0)
  v_and_b32_dpp v12, v79, v4 row_newbcast:0 row_mask:0xf bank_mask:0xf
  v_and_b32_dpp v13, v79, v5 row_newbcast:0 row_mask:0xf bank_mask:0xf
  v_and_b32_dpp v14, v79, v6 row_newbcast:0 row_mask:0xf bank_mask:0xf
  v_and_b32_dpp v15, v79, v7 row_newbcast:0 row_mask:0xf bank_mask:0xf
  v_and_b32_dpp v16, v79, v4 row_newbcast:8 row_mask:0xf bank_mask:0xf
  v_and_b32_dpp v17, v79, v5 row_newbcast:8 row_mask:0xf bank_mask:0xf
  v_and_b32_dpp v18, v79, v6 row_newbcast:8 row_mask:0xf bank_mask:0xf
  v_and_b32_dpp v19, v79, v7 row_newbcast:8 row_mask:0xf bank_mask:0xf
  v_mfma_f32_16x16x32_bf16 v[20:23], v[12:15], v[216:219], v[20:23]
  v_and_b32_dpp v12, v79, v4 row_newbcast:4 row_mask:0xf bank_mask:0xf
  v_and_b32_dpp v13, v79, v5 row_newbcast:4 row_mask:0xf bank_mask:0xf
  v_and_b32_dpp v14, v79, v6 row_newbcast:4 row_mask:0xf bank_mask:0xf
  v_and_b32_dpp v15, v79, v7 row_newbcast:4 row_mask:0xf bank_mask:0xf
L_hop3743:
  s_cbranch_execz L_hop3764
  v_mfma_f32_16x16x32_bf16 v[20:23], v[16:19], v[188:191], v[20:23]
  v_and_b32_dpp v16, v79, v4 row_newbcast:12 row_mask:0xf bank_mask:0xf
  v_and_b32_dpp v17, v79, v5 row_newbcast:12 row_mask:0xf bank_mask:0xf
  v_and_b32_dpp v18, v79, v6 row_newbcast:12 row_mask:0xf bank_mask:0xf
  v_and_b32_dpp v19, v79, v7 row_newbcast:12 row_mask:0xf bank_mask:0xf
  v_mfma_f32_16x16x32_bf16 v[20:23], v[12:15], v[184:187], v[20:23]
  s_nop 0
  v_mfma_f32_16x16x32_bf16 v[20:23], v[16:19], v[80:83], v[20:23]
  v_lshlrev_b32 v47, 5, v43
  v_lshl_add_u32 v47, v42, 4, v47
  s_lshl_b32 s77, s3, 9
  v_add_u32 v41, s77, v47
  v_lshl_add_u32 v45, v43, 2, v42
  v_lshlrev_b32 v45, 2, v45
  v_mov_b32 v46, 0xffffff00
  s_nop 0
  v_mul_f32 v20, v34, v20
  v_mul_f32 v21, v34, v21
  v_mul_f32 v22, v34, v22
  v_mul_f32 v23, v34, v23
L_hop3764:
  s_cbranch_execz L_hop3783
  s_mov_b64 exec, 0xffffffff
  ds_write_b128 v41, v[20:23] offset:2048
  s_mov_b64 exec, -1
  v_lshrrev_b32 v45, 1, v43
  v_lshl_add_u32 v45, v45, 2, v42
  v_lshlrev_b32 v45, 2, v45
  v_add_u32 v45, 2048, v45
  v_add_u32 v68, 1024, v45
  s_waitcnt lgkmcnt(0)
  s_barrier
  ds_read2_b32 v[52:53], v45 offset0:0 offset1:32
  ds_read2_b32 v[56:57], v45 offset0:128 offset1:160
  ds_read2_b32 v[60:61], v68 offset0:0 offset1:32
  ds_read2_b32 v[64:65], v68 offset0:128 offset1:160
  ds_read2_b32 v[54:55], v45 offset0:64 offset1:96
  ds_read2_b32 v[58:59], v45 offset0:192 offset1:224
  ds_read2_b32 v[62:63], v68 offset0:64 offset1:96
  ds_read2_b32 v[66:67], v68 offset0:192 offset1:224
L_hop3783:
  s_cbranch_execz L_hop3809
  v_and_b32 v70, 1, v43
  v_lshlrev_b32 v70, 4, v70
  v_mov_b32 v69, 0xffff
  v_lshlrev_b32 v69, v70, v69
  v_mov_b32 v12, 0
  v_mov_b32 v13, 0
  v_mov_b32 v14, 0
  v_mov_b32 v15, 0
  v_mov_b32 v16, 0
  v_mov_b32 v17, 0
  v_mov_b32 v18, 0
  v_mov_b32 v19, 0
  s_waitcnt lgkmcnt(4)
  v_add_f32 v52, v52, v56
  v_add_f32 v60, v60, v64
  v_add_f32 v52, v52, v60
  v_cvt_pk_bf16_f32 v24, v52, v52
  v_add_f32 v53, v53, v57
  v_add_f32 v61, v61, v65
  v_add_f32 v53, v53, v61
  v_cvt_pk_bf16_f32 v25, v53, v53
  v_and_b32_dpp v12, v24, v69 quad_perm:[0,1,2,3] row_mask:0xf bank_mask:0x1
  v_and_b32_dpp v13, v24, v69 row_ror:4 row_mask:0xf bank_mask:0x2
  v_and_b32_dpp v14, v24, v69 row_ror:8 row_mask:0xf bank_mask:0x4
  v_and_b32_dpp v15, v24, v69 row_ror:12 row_mask:0xf bank_mask:0x8
L_hop3809:
  s_cbranch_execz L_hop3828
  s_nop 1
  v_mfma_f32_16x16x32_bf16 v[28:31], v[12:15], v[196:199], 0
  v_and_b32_dpp v16, v24, v69 row_ror:12 row_mask:0xf bank_mask:0x1
  v_and_b32_dpp v17, v24, v69 quad_perm:[0,1,2,3] row_mask:0xf bank_mask:0x2
  v_and_b32_dpp v18, v24, v69 row_ror:4 row_mask:0xf bank_mask:0x4
  v_and_b32_dpp v19, v24, v69 row_ror:8 row_mask:0xf bank_mask:0x8
  v_mfma_f32_16x16x32_bf16 v[32:35], v[12:15], v[192:195], 0
  s_nop 0
  v_mfma_f32_16x16x32_bf16 v[28:31], v[16:19], v[240:243], v[28:31]
  v_and_b32_dpp v12, v24, v69 row_ror:8 row_mask:0xf bank_mask:0x1
  v_and_b32_dpp v13, v24, v69 row_ror:12 row_mask:0xf bank_mask:0x2
  v_and_b32_dpp v14, v24, v69 quad_perm:[0,1,2,3] row_mask:0xf bank_mask:0x4
  v_and_b32_dpp v15, v24, v69 row_ror:4 row_mask:0xf bank_mask:0x8
  v_mfma_f32_16x16x32_bf16 v[32:35], v[16:19], v[244:247], v[32:35]
  s_waitcnt lgkmcnt(0)
  v_add_f32 v54, v54, v58
  v_add_f32 v62, v62, v66
  v_add_f32 v54, v54, v62
L_hop3828:
  s_cbranch_execz L_hop3846
  v_cvt_pk_bf16_f32 v26, v54, v54
  v_mfma_f32_16x16x32_bf16 v[28:31], v[12:15], v[88:91], v[28:31]
  v_and_b32_dpp v16, v24, v69 row_ror:4 row_mask:0xf bank_mask:0x1
  v_and_b32_dpp v17, v24, v69 row_ror:8 row_mask:0xf bank_mask:0x2
  v_and_b32_dpp v18, v24, v69 row_ror:12 row_mask:0xf bank_mask:0x4
  v_and_b32_dpp v19, v24, v69 quad_perm:[0,1,2,3] row_mask:0xf bank_mask:0x8
  v_mfma_f32_16x16x32_bf16 v[32:35], v[12:15], v[92:95], v[32:35]
  v_add_f32 v55, v55, v59
  v_add_f32 v63, v63, v67
  v_add_f32 v55, v55, v63
  v_cvt_pk_bf16_f32 v27, v55, v55
  v_mfma_f32_16x16x32_bf16 v[28:31], v[16:19], v[112:115], v[28:31]
  v_and_b32_dpp v12, v25, v69 quad_perm:[0,1,2,3] row_mask:0xf bank_mask:0x1
  v_and_b32_dpp v13, v25, v69 row_ror:4 row_mask:0xf bank_mask:0x2
  v_and_b32_dpp v14, v25, v69 row_ror:8 row_mask:0xf bank_mask:0x4
  v_and_b32_dpp v15, v25, v69 row_ror:12 row_mask:0xf bank_mask:0x8
  v_mfma_f32_16x16x32_bf16 v[32:35], v[16:19], v[116:119], v[32:35]
L_hop3846:
  s_cbranch_execz L_hop3865
  v_lshrrev_b32 v70, 1, v42
  v_lshlrev_b32 v47, 5, v43
  v_lshl_add_u32 v47, v70, 4, v47
  v_mfma_f32_16x16x32_bf16 v[28:31], v[12:15], v[136:139], v[28:31]
  v_and_b32_dpp v16, v25, v69 row_ror:12 row_mask:0xf bank_mask:0x1
  v_and_b32_dpp v17, v25, v69 quad_perm:[0,1,2,3] row_mask:0xf bank_mask:0x2
  v_and_b32_dpp v18, v25, v69 row_ror:4 row_mask:0xf bank_mask:0x4
  v_and_b32_dpp v19, v25, v69 row_ror:8 row_mask:0xf bank_mask:0x8
  v_mfma_f32_16x16x32_bf16 v[32:35], v[12:15], v[140:143], v[32:35]
  s_nop 0
  v_mfma_f32_16x16x32_bf16 v[28:31], v[16:19], v[160:163], v[28:31]
  v_and_b32_dpp v12, v25, v69 row_ror:8 row_mask:0xf bank_mask:0x1
  v_and_b32_dpp v13, v25, v69 row_ror:12 row_mask:0xf bank_mask:0x2
  v_and_b32_dpp v14, v25, v69 quad_perm:[0,1,2,3] row_mask:0xf bank_mask:0x4
  v_and_b32_dpp v15, v25, v69 row_ror:4 row_mask:0xf bank_mask:0x8
  v_mfma_f32_16x16x32_bf16 v[32:35], v[16:19], v[164:167], v[32:35]
  s_nop 0
  v_mfma_f32_16x16x32_bf16 v[28:31], v[12:15], v[48:51], v[28:31]
L_hop3865:
  s_cbranch_execz L_hop3882
  v_and_b32_dpp v16, v25, v69 row_ror:4 row_mask:0xf bank_mask:0x1
  v_and_b32_dpp v17, v25, v69 row_ror:8 row_mask:0xf bank_mask:0x2
  v_and_b32_dpp v18, v25, v69 row_ror:12 row_mask:0xf bank_mask:0x4
  v_and_b32_dpp v19, v25, v69 quad_perm:[0,1,2,3] row_mask:0xf bank_mask:0x8
  v_mfma_f32_16x16x32_bf16 v[32:35], v[12:15], v[200:203], v[32:35]
  s_nop 0
  v_mfma_f32_16x16x32_bf16 v[28:31], v[16:19], v[224:227], v[28:31]
  v_and_b32_dpp v12, v26, v69 quad_perm:[0,1,2,3] row_mask:0xf bank_mask:0x1
  v_and_b32_dpp v13, v26, v69 row_ror:4 row_mask:0xf bank_mask:0x2
  v_and_b32_dpp v14, v26, v69 row_ror:8 row_mask:0xf bank_mask:0x4
  v_and_b32_dpp v15, v26, v69 row_ror:12 row_mask:0xf bank_mask:0x8
  v_mfma_f32_16x16x32_bf16 v[32:35], v[16:19], v[220:223], v[32:35]
  s_nop 0
  v_mfma_f32_16x16x32_bf16 v[28:31], v[12:15], v[236:239], v[28:31]
  v_and_b32_dpp v16, v26, v69 row_ror:12 row_mask:0xf bank_mask:0x1
  v_and_b32_dpp v17, v26, v69 quad_perm:[0,1,2,3] row_mask:0xf bank_mask:0x2
L_hop3882:
  s_cbranch_execz L_hop3900
  v_and_b32_dpp v18, v26, v69 row_ror:4 row_mask:0xf bank_mask:0x4
  v_and_b32_dpp v19, v26, v69 row_ror:8 row_mask:0xf bank_mask:0x8
  v_mfma_f32_16x16x32_bf16 v[32:35], v[12:15], v[248:251], v[32:35]
  s_nop 0
  v_mfma_f32_16x16x32_bf16 v[28:31], v[16:19], v[96:99], v[28:31]
  v_and_b32_dpp v12, v26, v69 row_ror:8 row_mask:0xf bank_mask:0x1
  v_and_b32_dpp v13, v26, v69 row_ror:12 row_mask:0xf bank_mask:0x2
  v_and_b32_dpp v14, v26, v69 quad_perm:[0,1,2,3] row_mask:0xf bank_mask:0x4
  v_and_b32_dpp v15, v26, v69 row_ror:4 row_mask:0xf bank_mask:0x8
  v_mfma_f32_16x16x32_bf16 v[32:35], v[16:19], v[100:103], v[32:35]
  s_nop 0
  v_mfma_f32_16x16x32_bf16 v[28:31], v[12:15], v[128:131], v[28:31]
  v_and_b32_dpp v16, v26, v69 row_ror:4 row_mask:0xf bank_mask:0x1
  v_and_b32_dpp v17, v26, v69 row_ror:8 row_mask:0xf bank_mask:0x2
  v_and_b32_dpp v18, v26, v69 row_ror:12 row_mask:0xf bank_mask:0x4
  v_and_b32_dpp v19, v26, v69 quad_perm:[0,1,2,3] row_mask:0xf bank_mask:0x8
  v_mfma_f32_16x16x32_bf16 v[32:35], v[12:15], v[132:135], v[32:35]
L_hop3900:
  s_cbranch_execz L_hop3918
  s_nop 0
  v_mfma_f32_16x16x32_bf16 v[28:31], v[16:19], v[168:171], v[28:31]
  v_and_b32_dpp v12, v27, v69 quad_perm:[0,1,2,3] row_mask:0xf bank_mask:0x1
  v_and_b32_dpp v13, v27, v69 row_ror:4 row_mask:0xf bank_mask:0x2
  v_and_b32_dpp v14, v27, v69 row_ror:8 row_mask:0xf bank_mask:0x4
  v_and_b32_dpp v15, v27, v69 row_ror:12 row_mask:0xf bank_mask:0x8
  v_mfma_f32_16x16x32_bf16 v[32:35], v[16:19], v[172:175], v[32:35]
  s_nop 0
  v_mfma_f32_16x16x32_bf16 v[28:31], v[12:15], v[208:211], v[28:31]
  v_and_b32_dpp v16, v27, v69 row_ror:12 row_mask:0xf bank_mask:0x1
  v_and_b32_dpp v17, v27, v69 quad_perm:[0,1,2,3] row_mask:0xf bank_mask:0x2
  v_and_b32_dpp v18, v27, v69 row_ror:4 row_mask:0xf bank_mask:0x4
  v_and_b32_dpp v19, v27, v69 row_ror:8 row_mask:0xf bank_mask:0x8
  v_mfma_f32_16x16x32_bf16 v[32:35], v[12:15], v[212:215], v[32:35]
  s_nop 0
  v_mfma_f32_16x16x32_bf16 v[28:31], v[16:19], v[232:235], v[28:31]
  v_and_b32_dpp v12, v27, v69 row_ror:8 row_mask:0xf bank_mask:0x1
L_hop3918:
  s_cbranch_execz L_hop3937
  v_and_b32_dpp v13, v27, v69 row_ror:12 row_mask:0xf bank_mask:0x2
  v_and_b32_dpp v14, v27, v69 quad_perm:[0,1,2,3] row_mask:0xf bank_mask:0x4
  v_and_b32_dpp v15, v27, v69 row_ror:4 row_mask:0xf bank_mask:0x8
  v_mfma_f32_16x16x32_bf16 v[32:35], v[16:19], v[252:255], v[32:35]
  s_nop 0
  v_mfma_f32_16x16x32_bf16 v[28:31], v[12:15], v[108:111], v[28:31]
  v_and_b32_dpp v16, v27, v69 row_ror:4 row_mask:0xf bank_mask:0x1
  v_and_b32_dpp v17, v27, v69 row_ror:8 row_mask:0xf bank_mask:0x2
  v_and_b32_dpp v18, v27, v69 row_ror:12 row_mask:0xf bank_mask:0x4
  v_and_b32_dpp v19, v27, v69 quad_perm:[0,1,2,3] row_mask:0xf bank_mask:0x8
  v_mfma_f32_16x16x32_bf16 v[32:35], v[12:15], v[120:123], v[32:35]
  s_nop 0
  v_mfma_f32_16x16x32_bf16 v[28:31], v[16:19], v[152:155], v[28:31]
  v_mfma_f32_16x16x32_bf16 v[32:35], v[16:19], v[156:159], v[32:35]
  s_nop 7
  v_add_f32 v52, v28, v34
  v_add_f32 v53, v29, v35
  v_add_u32 v52, 0x80, v52
L_hop3937:
  s_cbranch_execz L_hop4930
  v_add_u32 v53, 0x80, v53
  s_nop 0
  v_permlane16_swap_b32 v52, v54
  v_permlane16_swap_b32 v53, v55
  v_and_or_b32 v52, v52, v46, s24
  v_and_or_b32 v53, v53, v46, s25
  v_and_or_b32 v54, v54, v46, s26
  v_and_or_b32 v55, v55, v46, s27
  s_mov_b32 exec_lo, 0xffff
  s_mov_b32 exec_hi, 0xffff
  buffer_store_dwordx4 v[52:55], v47, s[64:67], s96 offen sc1
  s_mov_b64 exec, -1
  s_endpgm
  s_nop 9
L_comm:
  s_setprio 3
  v_mov_b32 v48, 0
  v_mov_b32 v52, -1
  v_mov_b32 v49, 0
  v_mov_b32 v53, -1
  v_mov_b32 v50, 0
  v_mov_b32 v54, -1
  v_mov_b32 v51, 0
  v_mov_b32 v55, -1
  v_mov_b32 v41, 0
  ds_write_b128 v41, v[48:51] offset:0
  ds_write_b128 v41, v[48:51] offset:16
  ds_write_b128 v41, v[48:51] offset:96
  ds_write_b128 v41, v[48:51] offset:112
  v_mov_b32 v31, 0
  s_and_b32 s98, s2, 7
  s_lshl_b32 s98, s98, 5
  s_waitcnt lgkmcnt(0)
  s_mov_b32 s12, s38
  s_mov_b32 s13, s39
  s_mov_b32 s14, 256
  s_mov_b32 s15, 0x00020000
  s_or_b32 s100, s100, 1
  v_mov_b32 v30, s100
  s_mov_b64 exec, 1
  buffer_atomic_cmpswap v[30:31], v41, s[12:15], s98 offen sc0 sc1
  s_mov_b64 exec, -1
  s_mov_b32 s64, s40
  s_mov_b32 s65, s41
  s_mov_b32 s66, 2885632
  s_mov_b32 s67, 0x00020000
  s_mov_b32 s60, s16
  s_mov_b32 s61, s17
  s_mov_b32 s62, 5120
  s_mov_b32 s63, 0x00020000
  s_mov_b32 s16, s34
  s_mov_b32 s17, s35
  s_mov_b32 s18, 1280
  s_mov_b32 s19, 0x00020000
  s_mov_b32 s20, s36
  s_mov_b32 s21, s37
  s_mov_b32 s22, 5120
  s_mov_b32 s23, 0x00020000
  s_mov_b32 s68, s24
  s_mov_b32 s69, s25
  s_mov_b32 s70, 5242880
  s_mov_b32 s71, 0x00020000
  s_barrier
  s_mul_i32 s98, s94, 163840
  s_add_u32 s98, s98, 1024
  s_mul_i32 s96, s73, 2560
  s_add_u32 s96, s96, 67584
  v_and_b32 v38, 7, v40
  v_mul_u32_u24 v3, 1280, v42
  v_lshl_add_u32 v3, v43, 4, v3
  v_lshrrev_b32 v45, 1, v38
  v_and_b32 v46, 1, v40
  v_lshlrev_b32 v46, 4, v46
  v_mov_b32 v41, 0xffff
  v_lshlrev_b32 v46, v46, v41
  v_cmp_eq_u32 vcc, 0, v45
  s_nop 1
  v_cndmask_b32 v4, 0, v46, vcc
  v_cmp_eq_u32 vcc, 1, v45
  s_nop 1
  v_cndmask_b32 v5, 0, v46, vcc
  v_cmp_eq_u32 vcc, 2, v45
  s_nop 1
  v_cndmask_b32 v6, 0, v46, vcc
  v_cmp_eq_u32 vcc, 3, v45
  s_nop 1
  v_cndmask_b32 v7, 0, v46, vcc
  s_sub_u32 s76, s2, 121
  s_cmp_lt_u32 s76, 135
  s_cselect_b32 s75, s76, 0
  s_cselect_b32 s76, 0, 0x40000000
  s_mul_i32 s74, s75, 205
  s_lshr_b32 s74, s74, 10
  s_mul_i32 s77, s74, 5
  s_sub_u32 s75, s75, s77
  s_mov_b32 s54, s76
  s_mov_b32 s7, s74
  s_lshl_b32 s47, s74, 8
  s_add_u32 s47, s47, 1114112
  s_mul_i32 s48, s75, 27
  s_add_u32 s48, s48, s74
  s_lshl_b32 s48, s48, 11
  s_add_u32 s48, s48, 786432
  s_and_b32 s74, s73, 63
  s_cmp_lt_u32 s74, 40
  s_cselect_b32 s53, 0, 0x40000000
  s_cselect_b32 s74, s74, 0
  s_mul_i32 s72, s81, 1280
  v_mul_u32_u24 v41, 20, v40
  v_or_b32 v41, s53, v41
  buffer_load_dwordx4 v[96:99], v41, s[60:63], s72 offen
  buffer_load_dword v104, v41, s[60:63], s72 offen offset:16
  buffer_load_dwordx4 v[100:103], v41, s[16:19], 0 offen
  buffer_load_dword v105, v41, s[16:19], 0 offen offset:16
  s_lshl_b32 s77, s74, 5
  s_add_u32 s52, s72, s77
  s_mul_i32 s51, s81, 163840
  s_lshl_b32 s77, s74, 6
  s_add_u32 s51, s51, s77
  s_add_u32 s51, s51, 65536
  s_lshr_b32 s75, s74, 3
  s_mul_i32 s49, s75, 55296
  s_add_u32 s8, s75, 121
  s_and_b32 s75, s74, 7
  s_lshl_b32 s75, s75, 6
  s_add_u32 s49, s49, s75
  s_lshl_b32 s75, s81, 9
  s_add_u32 s49, s49, s75
  s_add_u32 s49, s49, 786432
  s_lshl_b32 s45, s94, 12
  s_add_u32 s45, s45, 1376256
  s_lshl_b32 s75, s81, 1
  s_add_u32 s75, s75, s95
  s_lshl_b32 s75, s75, 8
  s_add_u32 s44, s45, s75
  s_lshl_b32 s75, s81, 10
  s_add_u32 s45, s45, s75
  s_sub_u32 s77, s2, 128
  s_and_b32 s77, s77, 127
  s_mul_i32 s74, s77, 1214
  s_lshr_b32 s74, s74, 15
  s_mul_i32 s75, s74, 27
  s_sub_u32 s75, s77, s75
  s_mul_i32 s46, s74, 27648
  s_lshl_b32 s75, s75, 8
  s_add_u32 s46, s46, s75
  s_add_u32 s46, s46, 1114112
  s_cmp_lt_u32 s2, 128
  s_cselect_b32 s44, s44, s46
  s_movk_i32 s75, 6912
  s_cselect_b32 s75, 1024, s75
  s_cmp_lt_u32 s2, 236
  s_cselect_b32 s44, s44, 1114112
  s_cselect_b32 s77, 0, 0x40000000
  v_mul_u32_u24 v32, s75, v42
  v_lshl_add_u32 v32, v43, 4, v32
  v_or_b32 v32, s77, v32
  v_mul_u32_u24 v33, 6912, v42
  v_lshl_add_u32 v33, v43, 4, v33
  s_lshl_b32 s50, s73, 4
  s_add_u32 s50, s50, 0
  s_lshr_b32 s77, s54, 30
  v_mov_b32 v41, 0
  v_mov_b32 v44, s77
  ds_write_b32 v41, v44 offset:20
  s_mov_b32 s4, 0x0c0c0400
  s_mov_b32 s5, 0x04000c0c
  s_mov_b32 s6, 0xffffff00
  s_movk_i32 s11, -200
L_wseg4:
  s_nop 0
  s_waitcnt vmcnt(4)
  v_readfirstlane_b32 s74, v30
  s_nop 0
  s_cmp_eq_u32 s74, 0
  s_cselect_b32 s100, s100, s74
  v_mov_b32 v44, s100
  ds_write_b32 v41, v44 offset:28
  s_mov_b32 s9, s100
  s_mul_i32 s100, s100, 0x9e3779b1
  s_bfe_u32 s56, s100, 524288
  s_bfe_u32 s57, s100, 524296
  s_bfe_u32 s58, s100, 524304
  s_bfe_u32 s59, s100, 524312
  v_mov_b32 v46, 0xffffff00
  s_nop 0
  v_mov_b32 v41, 0
  s_mov_b32 s97, 0
  s_nop 9
L_sp129:
  ds_read_b32 v44, v41 offset:0
  s_add_u32 s97, s97, 1
  s_waitcnt lgkmcnt(0)
  v_cmp_le_u32 vcc, 4, v44
  s_cbranch_vccnz L_ok128
  s_cmp_gt_u32 s97, 4000000
  s_cbranch_scc1 L_ok128
  s_sleep 1
  s_branch L_sp129
  s_nop 9
L_ok128:
  ds_read_b128 v[48:51], v1 offset:4096
  ds_read_b128 v[52:55], v1 offset:5120
  ds_read_b128 v[56:59], v1 offset:6144
  ds_read_b128 v[60:63], v1 offset:7168
  ds_read_b128 v[64:67], v1 offset:8192
  ds_read_b128 v[68:71], v1 offset:9216
  ds_read_b128 v[72:75], v1 offset:10240
  ds_read_b128 v[76:79], v1 offset:11264
  s_nop 0
  s_waitcnt lgkmcnt(6)
  v_add_f32 v48, v48, v52
  v_add_f32 v49, v49, v53
  v_add_f32 v50, v50, v54
  v_add_f32 v51, v51, v55
  s_waitcnt lgkmcnt(4)
  v_add_f32 v56, v56, v60
  v_add_f32 v57, v57, v61
  v_add_f32 v58, v58, v62
  v_add_f32 v59, v59, v63
  s_waitcnt lgkmcnt(2)
  v_add_f32 v64, v64, v68
  v_add_f32 v65, v65, v69
  v_add_f32 v66, v66, v70
  v_add_f32 v67, v67, v71
  s_waitcnt lgkmcnt(0)
  v_add_f32 v72, v72, v76
  v_add_f32 v73, v73, v77
  v_add_f32 v74, v74, v78
  v_add_f32 v75, v75, v79
  v_add_f32 v48, v48, v56
  v_add_f32 v64, v64, v72
  v_add_f32 v49, v49, v57
  v_add_f32 v65, v65, v73
  v_add_f32 v50, v50, v58
  v_add_f32 v66, v66, v74
  v_add_f32 v51, v51, v59
  v_add_f32 v67, v67, v75
  v_add_f32 v80, v48, v64
  v_add_f32 v81, v49, v65
  v_add_f32 v82, v50, v66
  s_nop 0
  v_add_f32 v83, v51, v67
  v_add_u32 v80, 0x80, v80
  v_add_u32 v81, 0x80, v81
  v_add_u32 v82, 0x80, v82
  v_add_u32 v83, 0x80, v83
  v_and_or_b32 v80, v80, v46, s56
  v_and_or_b32 v81, v81, v46, s57
  v_and_or_b32 v82, v82, v46, s58
  v_and_or_b32 v83, v83, v46, s59
  buffer_store_dwordx4 v[80:83], v32, s[64:67], s44 offen sc1
  s_nop 9
L_cw130:
  s_memrealtime s[42:43]
  s_waitcnt lgkmcnt(0)
  s_sub_u32 s42, s42, s9
  s_cmp_ge_u32 s42, 450
  s_cbranch_scc1 L_ok131
  s_sleep 2
  s_branch L_cw130
  s_nop 9
L_ok131:
  v_and_b32 v44, 7, v40
  s_nop 0
  v_lshlrev_b32 v35, 5, v44
  buffer_load_dword v37, v35, s[12:15], 0 offen sc1
  s_mov_b64 s[24:25], -1
  s_mov_b32 s97, 0
  s_nop 9
L_sp133:
  s_mov_b64 exec, s[24:25]
  buffer_load_dwordx4 v[48:51], v1, s[64:67], s45 offen offset:0 sc1
  s_mov_b64 exec, -1
  s_add_u32 s97, s97, 1
  s_waitcnt vmcnt(0)
  v_perm_b32 v56, v49, v48, s4
  v_perm_b32 v57, v51, v50, s5
  v_or_b32 v56, v56, v57
  s_mov_b64 exec, s[24:25]
  v_cmp_ne_u32 s[24:25], s100, v56
  s_mov_b64 exec, -1
  s_or_b64 s[74:75], s[24:25], s[24:25]
  s_cbranch_scc0 L_ok132
  s_cmp_gt_u32 s97, 20000
  s_cbranch_scc1 L_ok132
  s_sleep 1
  s_branch L_sp133
  s_nop 9
L_ok132:
  v_and_b32 v48, s6, v48
  v_and_b32 v49, s6, v49
  s_nop 0
  v_and_b32 v50, s6, v50
  v_and_b32 v51, s6, v51
  v_cmp_eq_u32 vcc, 0, v37
  s_cbranch_vccz L_nt135
  s_mov_b32 s97, 0
  s_nop 9
L_sp137:
  buffer_load_dword v37, v35, s[12:15], 0 offen sc1
  s_add_u32 s97, s97, 1
  s_waitcnt vmcnt(0)
  v_cmp_eq_u32 vcc, 0, v37
  s_cbranch_vccz L_ok136
  s_cmp_gt_u32 s97, 20000
  s_cbranch_scc1 L_ok136
  s_sleep 16
  s_branch L_sp137
  s_nop 9
L_ok136:
  s_nop 9
L_nt135:
  v_subrev_u32 v60, s9, v37
  v_max_i32 v60, s11, v60
  v_min_i32 v60, 200, v60
  s_nop 1
  v_add_u32_dpp v62, v60, v60 quad_perm:[1,0,3,2] row_mask:0xf bank_mask:0xf
  s_nop 1
  v_add_u32_dpp v62, v62, v62 quad_perm:[2,3,0,1] row_mask:0xf bank_mask:0xf
  s_nop 1
  v_add_u32_dpp v62, v62, v62 row_ror:4 row_mask:0xf bank_mask:0xf
  s_nop 0
  v_ashrrev_i32 v62, 3, v62
  v_min_i32_dpp v60, v60, v60 quad_perm:[1,0,3,2] row_mask:0xf bank_mask:0xf
  s_nop 1
  v_min_i32_dpp v60, v60, v60 quad_perm:[2,3,0,1] row_mask:0xf bank_mask:0xf
  s_nop 1
  v_min_i32_dpp v60, v60, v60 row_ror:4 row_mask:0xf bank_mask:0xf
  v_max_i32 v60, s11, v60
  v_sub_u32 v62, v62, v60
  v_mul_u32_u24 v62, 8, v62
  v_lshrrev_b32 v62, 3, v62
  v_add_u32 v60, v60, v62
  v_mov_b32 v61, 0
  ds_write_b32 v61, v60 offset:128
  v_readfirstlane_b32 s10, v60
  s_nop 0
  s_add_u32 s9, s9, s10
  v_mov_b32 v52, v48
  v_mov_b32 v53, v49
  v_mov_b32 v54, v50
  v_mov_b32 v55, v51
  v_permlane32_swap_b32 v48, v52
  v_permlane32_swap_b32 v49, v53
  v_permlane32_swap_b32 v50, v54
  v_permlane32_swap_b32 v51, v55
  v_add_f32 v48, v48, v52
  v_add_f32 v49, v49, v53
  s_nop 0
  v_add_f32 v50, v50, v54
  v_add_f32 v51, v51, v55
  v_cvt_pk_bf16_f32 v56, v48, v49
  v_cvt_pk_bf16_f32 v57, v50, v51
  v_lshlrev_b32 v44, 3, v40
  v_mov_b32 v41, 0
  v_mov_b32 v45, 1
  s_mov_b64 exec, 0xffffffff
  ds_write_b64 v44, v[56:57] offset:256
  s_mov_b64 exec, 1
  ds_write_b32 v41, v45 offset:16
  s_mov_b64 exec, -1
  v_mov_b32 v20, 0
  v_lshlrev_b32 v48, 16, v96
  v_and_b32 v49, s80, v96
  v_lshlrev_b32 v50, 16, v100
  v_and_b32 v51, s80, v100
  v_mul_f32 v48, v48, v50
  v_mul_f32 v49, v49, v51
  v_cvt_pk_bf16_f32 v48, v48, v49
  v_lshlrev_b32 v49, 16, v48
  v_and_b32 v48, s80, v48
  v_add_f32 v20, v20, v49
  v_add_f32 v20, v20, v48
  v_lshlrev_b32 v48, 16, v97
  s_nop 0
  v_and_b32 v49, s80, v97
  v_lshlrev_b32 v50, 16, v101
  v_and_b32 v51, s80, v101
  v_mul_f32 v48, v48, v50
  v_mul_f32 v49, v49, v51
  v_cvt_pk_bf16_f32 v48, v48, v49
  v_lshlrev_b32 v49, 16, v48
  v_and_b32 v48, s80, v48
  v_add_f32 v20, v20, v49
  v_add_f32 v20, v20, v48
  v_lshlrev_b32 v48, 16, v98
  v_and_b32 v49, s80, v98
  v_lshlrev_b32 v50, 16, v102
  v_and_b32 v51, s80, v102
  v_mul_f32 v48, v48, v50
  v_mul_f32 v49, v49, v51
  v_cvt_pk_bf16_f32 v48, v48, v49
  v_lshlrev_b32 v49, 16, v48
  v_and_b32 v48, s80, v48
  v_add_f32 v20, v20, v49
  v_add_f32 v20, v20, v48
  v_lshlrev_b32 v48, 16, v99
  v_and_b32 v49, s80, v99
  v_lshlrev_b32 v50, 16, v103
  v_and_b32 v51, s80, v103
  v_mul_f32 v48, v48, v50
  v_mul_f32 v49, v49, v51
  v_cvt_pk_bf16_f32 v48, v48, v49
  s_nop 0
  v_lshlrev_b32 v49, 16, v48
  v_and_b32 v48, s80, v48
  v_add_f32 v20, v20, v49
  v_add_f32 v20, v20, v48
  v_lshlrev_b32 v48, 16, v104
  v_and_b32 v49, s80, v104
  v_lshlrev_b32 v50, 16, v105
  v_and_b32 v51, s80, v105
  v_mul_f32 v48, v48, v50
  v_mul_f32 v49, v49, v51
  v_cvt_pk_bf16_f32 v48, v48, v49
  v_lshlrev_b32 v49, 16, v48
  v_and_b32 v48, s80, v48
  v_add_f32 v20, v20, v49
  v_add_f32 v20, v20, v48
  s_nop 1
  v_add_f32_dpp v20, v20, v20 quad_perm:[1,0,3,2] row_mask:0xf bank_mask:0xf
  s_nop 1
  v_add_f32_dpp v20, v20, v20 quad_perm:[2,3,0,1] row_mask:0xf bank_mask:0xf
  s_nop 1
  v_add_f32_dpp v20, v20, v20 row_ror:4 row_mask:0xf bank_mask:0xf
  s_nop 1
  v_add_f32_dpp v20, v20, v20 row_ror:8 row_mask:0xf bank_mask:0xf
  v_mov_b32 v48, v20
  s_nop 1
  v_permlane16_swap_b32 v20, v48
  s_nop 0
  v_add_f32 v20, v20, v48
  v_mov_b32 v48, v20
  s_nop 1
  v_permlane32_swap_b32 v20, v48
  v_add_f32 v20, v20, v48
  v_cvt_pk_bf16_f32 v20, v20, v20
  v_and_b32 v20, s80, v20
  v_mul_f32 v20, s78, v20
  v_exp_f32 v20, -v20
  s_nop 0
  v_add_f32 v20, 1.0, v20
  v_rcp_f32 v20, v20
  s_nop 0
  v_cvt_pk_bf16_f32 v20, v20, v20
  v_and_b32 v20, s80, v20
  v_sub_f32 v21, 1.0, v20
  v_cvt_pk_bf16_f32 v21, v21, v21
  v_and_b32 v21, s80, v21
  s_mov_b32 s77, 0x9e3779b1
  v_mul_lo_u32 v37, v37, s77
  s_movk_i32 s55, 400
  s_cmp_eq_u32 s54, 0
  s_cbranch_scc1 L_has2139
  s_mov_b64 exec, 0
  s_branch L_wseg0
L_wret0a:
  s_mov_b64 exec, -1
  s_nop 0
  s_branch L_no2138
L_has2139:
  s_add_u32 s77, s7, 0
  s_and_b32 s77, s77, 7
  v_readlane_b32 s12, v37, s77
  s_add_u32 s77, s7, 27
  s_and_b32 s77, s77, 7
  v_readlane_b32 s13, v37, s77
  s_add_u32 s77, s7, 54
  s_and_b32 s77, s77, 7
  v_readlane_b32 s14, v37, s77
  s_add_u32 s77, s7, 81
  s_and_b32 s77, s77, 7
  v_readlane_b32 s15, v37, s77
  s_mov_b64 s[24:25], -1
  s_mov_b64 s[26:27], -1
  s_mov_b64 s[28:29], -1
  s_mov_b64 s[30:31], -1
  s_mov_b32 s97, 0
  s_nop 9
L_sp141:
  s_mov_b64 exec, s[24:25]
  s_add_u32 s77, s47, 0
  buffer_load_dwordx4 v[48:51], v33, s[64:67], s77 offen sc1
  s_mov_b64 exec, s[26:27]
  s_add_u32 s77, s47, 27648
  buffer_load_dwordx4 v[52:55], v33, s[64:67], s77 offen sc1
  s_mov_b64 exec, s[28:29]
  s_add_u32 s77, s47, 55296
  buffer_load_dwordx4 v[56:59], v33, s[64:67], s77 offen sc1
  s_mov_b64 exec, s[30:31]
  s_add_u32 s77, s47, 82944
  buffer_load_dwordx4 v[60:63], v33, s[64:67], s77 offen sc1
  s_mov_b64 exec, -1
  s_add_u32 s97, s97, 1
  s_waitcnt vmcnt(3)
  v_perm_b32 v80, v49, v48, s4
  v_perm_b32 v81, v51, v50, s5
  s_waitcnt vmcnt(2)
  v_perm_b32 v82, v53, v52, s4
  v_perm_b32 v83, v55, v54, s5
  s_waitcnt vmcnt(1)
  v_perm_b32 v84, v57, v56, s4
  v_perm_b32 v85, v59, v58, s5
  s_waitcnt vmcnt(0)
  v_perm_b32 v86, v61, v60, s4
  v_perm_b32 v87, v63, v62, s5
  v_or_b32 v80, v80, v81
  v_or_b32 v82, v82, v83
  v_or_b32 v84, v84, v85
  v_or_b32 v86, v86, v87
  s_mov_b64 exec, s[24:25]
  v_cmp_ne_u32 s[24:25], s12, v80
  s_mov_b64 exec, s[26:27]
  v_cmp_ne_u32 s[26:27], s13, v82
  s_mov_b64 exec, s[28:29]
  v_cmp_ne_u32 s[28:29], s14, v84
  s_mov_b64 exec, s[30:31]
  v_cmp_ne_u32 s[30:31], s15, v86
  s_mov_b64 exec, -1
  s_or_b64 s[74:75], s[24:25], s[26:27]
  s_or_b64 s[74:75], s[74:75], s[28:29]
  s_or_b64 s[74:75], s[74:75], s[30:31]
  s_cbranch_scc0 L_ok140
  s_cmp_gt_u32 s97, 20000
  s_cbranch_scc1 L_ok140
  s_sleep 4
  s_branch L_sp141
  s_nop 0
  s_nop 9
L_ok140:
  v_and_b32 v48, s6, v48
  s_nop 0
  v_and_b32 v49, s6, v49
  v_and_b32 v50, s6, v50
  v_and_b32 v51, s6, v51
  v_and_b32 v52, s6, v52
  v_and_b32 v53, s6, v53
  v_and_b32 v54, s6, v54
  v_and_b32 v55, s6, v55
  v_and_b32 v56, s6, v56
  v_and_b32 v57, s6, v57
  v_and_b32 v58, s6, v58
  v_and_b32 v59, s6, v59
  v_and_b32 v60, s6, v60
  v_and_b32 v61, s6, v61
  v_and_b32 v62, s6, v62
  v_and_b32 v63, s6, v63
  v_lshrrev_b32 v41, 2, v43
  v_and_b32 v44, 3, v43
  v_lshlrev_b32 v41, 8, v41
  v_lshl_add_u32 v41, v42, 4, v41
  v_lshl_add_u32 v41, v44, 2, v41
  v_add_f32 v48, v48, v56
  v_add_f32 v49, v49, v57
  v_add_f32 v50, v50, v58
  v_add_f32 v51, v51, v59
  v_add_f32 v52, v52, v60
  v_add_f32 v53, v53, v61
  v_add_f32 v54, v54, v62
  v_add_f32 v55, v55, v63
  v_cvt_pk_bf16_f32 v56, v48, v52
  s_nop 0
  v_cvt_pk_bf16_f32 v57, v49, v53
  v_cvt_pk_bf16_f32 v58, v50, v54
  v_cvt_pk_bf16_f32 v59, v51, v55
  v_lshlrev_b32 v60, 16, v56
  v_and_b32 v56, s80, v56
  v_lshlrev_b32 v61, 16, v57
  v_and_b32 v57, s80, v57
  v_lshlrev_b32 v62, 16, v58
  v_and_b32 v58, s80, v58
  v_lshlrev_b32 v63, 16, v59
  v_and_b32 v59, s80, v59
  v_mul_f32 v56, v56, v60
  v_mul_f32 v57, v57, v61
  v_mul_f32 v58, v58, v62
  v_mul_f32 v59, v59, v63
  v_cvt_pk_bf16_f32 v56, v56, v56
  v_cvt_pk_bf16_f32 v57, v57, v57
  v_cvt_pk_bf16_f32 v58, v58, v58
  v_cvt_pk_bf16_f32 v59, v59, v59
  ds_write_b32 v41, v56 offset:512
  ds_write_b32 v41, v57 offset:576
  s_nop 0
  ds_write_b32 v41, v58 offset:640
  ds_write_b32 v41, v59 offset:704
  v_mov_b32 v41, 0
  v_mov_b32 v45, 1
  ds_write_b32 v41, v45 offset:20
  s_mov_b64 exec, 0
  s_branch L_wseg0
L_wret0b:
  s_mov_b64 exec, -1
  v_mov_b32 v41, 0
  s_mov_b32 s97, 0
  s_nop 9
L_sp144:
  ds_read_b32 v44, v41 offset:8
  s_add_u32 s97, s97, 1
  s_waitcnt lgkmcnt(0)
  v_cmp_le_u32 vcc, 4, v44
  s_cbranch_vccnz L_ok143
  s_cmp_gt_u32 s97, 4000000
  s_cbranch_scc1 L_ok143
  s_sleep 1
  s_branch L_sp144
  s_nop 9
L_ok143:
  ds_read_b128 v[48:51], v1 offset:4096
  ds_read_b128 v[52:55], v1 offset:5120
  ds_read_b128 v[56:59], v1 offset:6144
  s_nop 0
  ds_read_b128 v[60:63], v1 offset:7168
  ds_read_b128 v[64:67], v1 offset:8192
  ds_read_b128 v[68:71], v1 offset:9216
  ds_read_b128 v[72:75], v1 offset:10240
  ds_read_b128 v[76:79], v1 offset:11264
  s_waitcnt lgkmcnt(0)
  v_add_f32 v48, v48, v56
  v_add_f32 v64, v64, v72
  v_add_f32 v49, v49, v57
  v_add_f32 v65, v65, v73
  v_add_f32 v50, v50, v58
  v_add_f32 v66, v66, v74
  v_add_f32 v51, v51, v59
  v_add_f32 v67, v67, v75
  v_add_f32 v52, v52, v60
  v_add_f32 v68, v68, v76
  v_add_f32 v53, v53, v61
  v_add_f32 v69, v69, v77
  v_add_f32 v54, v54, v62
  v_add_f32 v70, v70, v78
  v_add_f32 v55, v55, v63
  v_add_f32 v71, v71, v79
  v_add_f32 v48, v48, v64
  v_add_f32 v49, v49, v65
  v_add_f32 v50, v50, v66
  s_nop 0
  v_add_f32 v51, v51, v67
  v_add_f32 v52, v52, v68
  v_add_f32 v53, v53, v69
  v_add_f32 v54, v54, v70
  v_add_f32 v55, v55, v71
  v_add_u32 v48, 0x80, v48
  v_add_u32 v49, 0x80, v49
  v_add_u32 v50, 0x80, v50
  v_add_u32 v51, 0x80, v51
  v_add_u32 v52, 0x80, v52
  v_add_u32 v53, 0x80, v53
  v_add_u32 v54, 0x80, v54
  v_add_u32 v55, 0x80, v55
  v_and_or_b32 v48, v48, v46, s56
  v_and_or_b32 v49, v49, v46, s57
  v_and_or_b32 v50, v50, v46, s58
  v_and_or_b32 v51, v51, v46, s59
  v_and_or_b32 v52, v52, v46, s56
  s_nop 0
  v_and_or_b32 v53, v53, v46, s57
  v_and_or_b32 v54, v54, v46, s58
  v_and_or_b32 v55, v55, v46, s59
  v_mov_b32 v120, v48
  v_mov_b32 v121, v49
  v_mov_b32 v122, v50
  v_mov_b32 v123, v51
  v_mov_b32 v124, v52
  v_mov_b32 v125, v53
  v_mov_b32 v126, v54
  v_mov_b32 v127, v55
  s_nop 9
L_no2138:
  s_mov_b64 exec, 0
  s_branch L_wseg1
L_wret1:
  s_mov_b64 exec, -1
  s_mov_b64 exec, 0
  s_branch L_wseg2
L_wret2:
  s_mov_b64 exec, -1
  v_mov_b32 v41, 0
  s_mov_b32 s97, 0
  s_nop 9
L_sp146:
  ds_read_b32 v44, v41 offset:12
  s_add_u32 s97, s97, 1
  s_waitcnt lgkmcnt(0)
  v_cmp_le_u32 vcc, 4, v44
  s_cbranch_vccnz L_ok145
  s_cmp_gt_u32 s97, 4000000
  s_cbranch_scc1 L_ok145
  s_sleep 1
  s_branch L_sp146
  s_nop 9
L_ok145:
  v_and_b32 v45, 3, v40
  v_lshlrev_b32 v44, 3, v45
  ds_read_b64 v[80:81], v44 offset:64
  s_waitcnt lgkmcnt(0)
  v_max_f32_dpp v84, v80, v80 quad_perm:[1,0,3,2] row_mask:0xf bank_mask:0xf
  s_nop 1
  v_max_f32_dpp v84, v84, v84 quad_perm:[2,3,0,1] row_mask:0xf bank_mask:0xf
  v_sub_f32 v41, v80, v84
  v_mul_f32 v41, s78, v41
  v_exp_f32 v41, v41
  s_nop 0
  v_mul_f32 v86, v41, v81
  s_nop 1
  v_add_f32_dpp v86, v86, v86 quad_perm:[1,0,3,2] row_mask:0xf bank_mask:0xf
  s_nop 1
  v_add_f32_dpp v86, v86, v86 quad_perm:[2,3,0,1] row_mask:0xf bank_mask:0xf
  v_mov_b32 v85, s100
  v_mov_b32 v87, s100
  s_mov_b64 exec, 1
  buffer_store_dwordx4 v[84:87], off, s[64:67], s50 sc1
  s_mov_b64 exec, -1
  s_xor_b32 s50, s50, 16
  s_mov_b32 s97, 0
  s_nop 9
L_sp148:
  buffer_load_dwordx4 v[48:51], off, s[64:67], s50 sc1
  s_add_u32 s97, s97, 1
  s_waitcnt vmcnt(0)
  v_xor_b32 v41, s100, v49
  v_xor_b32 v44, s100, v51
  v_or_b32 v41, v41, v44
  v_cmp_ne_u32 vcc, 0, v41
  s_cbranch_vccz L_ok147
  s_cmp_gt_u32 s97, 20000
  s_cbranch_scc1 L_ok147
  s_sleep 8
  s_branch L_sp148
  s_nop 9
L_ok147:
  v_max_f32 v52, v84, v48
  v_sub_f32 v53, v84, v52
  v_sub_f32 v54, v48, v52
  v_sub_f32 v55, v80, v52
  v_mul_f32 v53, s78, v53
  v_mul_f32 v54, s78, v54
  v_mul_f32 v55, s78, v55
  v_exp_f32 v53, v53
  v_exp_f32 v54, v54
  v_exp_f32 v55, v55
  v_mul_f32 v53, v53, v86
  v_fma_f32 v53, v54, v50, v53
  v_rcp_f32 v53, v53
  v_lshlrev_b32 v44, 2, v45
  v_mul_f32 v55, v55, v53
  v_mov_b32 v41, 0
  v_mov_b32 v45, 1
  s_mov_b64 exec, 15
  ds_write_b32 v44, v55 offset:32
  ds_write_b32 v41, v45 offset:24
  s_mov_b64 exec, -1
  s_nop 9
L_cw149:
  s_memrealtime s[42:43]
  s_waitcnt lgkmcnt(0)
  s_sub_u32 s42, s42, s9
  s_cmp_ge_u32 s42, 2800
  s_cbranch_scc1 L_ok150
  s_sleep 2
  s_branch L_cw149
  s_nop 9
L_ok150:
  buffer_load_dwordx4 v[128:131], v3, s[68:71], s98 offen nt
  s_add_u32 s98, s98, 5120
  buffer_load_dwordx4 v[132:135], v3, s[68:71], s98 offen nt
  s_add_u32 s98, s98, 5120
  s_nop 9
L_cw151:
  s_memrealtime s[42:43]
  s_waitcnt lgkmcnt(0)
  s_sub_u32 s42, s42, s9
  s_cmp_ge_u32 s42, 2856
  s_cbranch_scc1 L_ok152
  s_sleep 2
  s_branch L_cw151
  s_nop 9
L_ok152:
  buffer_load_dwordx4 v[136:139], v3, s[68:71], s98 offen nt
  s_add_u32 s98, s98, 5120
  buffer_load_dwordx4 v[140:143], v3, s[68:71], s98 offen nt
  s_add_u32 s98, s98, 5120
  s_nop 9
L_cw153:
  s_memrealtime s[42:43]
  s_waitcnt lgkmcnt(0)
  s_sub_u32 s42, s42, s9
  s_cmp_ge_u32 s42, 2912
  s_cbranch_scc1 L_ok154
  s_sleep 2
  s_branch L_cw153
  s_nop 9
L_ok154:
  buffer_load_dwordx4 v[144:147], v3, s[68:71], s98 offen nt
  s_add_u32 s98, s98, 5120
  buffer_load_dwordx4 v[148:151], v3, s[68:71], s98 offen nt
  s_add_u32 s98, s98, 5120
  s_nop 9
L_cw155:
  s_memrealtime s[42:43]
  s_waitcnt lgkmcnt(0)
  s_sub_u32 s42, s42, s9
  s_cmp_ge_u32 s42, 2968
  s_cbranch_scc1 L_ok156
  s_sleep 2
  s_branch L_cw155
  s_nop 9
L_ok156:
  buffer_load_dwordx4 v[152:155], v3, s[68:71], s98 offen nt
  s_add_u32 s98, s98, 5120
  buffer_load_dwordx4 v[156:159], v3, s[68:71], s98 offen nt
  s_add_u32 s98, s98, 5120
  s_nop 9
L_cw157:
  s_memrealtime s[42:43]
  s_waitcnt lgkmcnt(0)
  s_sub_u32 s42, s42, s9
  s_cmp_ge_u32 s42, 3024
  s_cbranch_scc1 L_ok158
  s_sleep 2
  s_branch L_cw157
  s_nop 9
L_ok158:
  buffer_load_dwordx4 v[160:163], v3, s[68:71], s98 offen nt
  s_add_u32 s98, s98, 5120
  buffer_load_dwordx4 v[164:167], v3, s[68:71], s98 offen nt
  s_add_u32 s98, s98, 5120
  s_nop 9
L_cw159:
  s_memrealtime s[42:43]
  s_waitcnt lgkmcnt(0)
  s_sub_u32 s42, s42, s9
  s_cmp_ge_u32 s42, 3080
  s_cbranch_scc1 L_ok160
  s_sleep 2
  s_branch L_cw159
  s_nop 9
L_ok160:
  buffer_load_dwordx4 v[168:171], v3, s[68:71], s98 offen nt
  s_add_u32 s98, s98, 5120
  buffer_load_dwordx4 v[172:175], v3, s[68:71], s98 offen nt
  s_add_u32 s98, s98, 5120
  s_nop 9
L_cw161:
  s_memrealtime s[42:43]
  s_waitcnt lgkmcnt(0)
  s_sub_u32 s42, s42, s9
  s_cmp_ge_u32 s42, 3136
  s_cbranch_scc1 L_ok162
  s_sleep 2
  s_branch L_cw161
  s_nop 9
L_ok162:
  buffer_load_dwordx4 v[176:179], v3, s[68:71], s98 offen nt
  s_add_u32 s98, s98, 5120
  buffer_load_dwordx4 v[180:183], v3, s[68:71], s98 offen nt
  s_add_u32 s98, s98, 5120
  s_nop 9
L_cw163:
  s_memrealtime s[42:43]
  s_waitcnt lgkmcnt(0)
  s_sub_u32 s42, s42, s9
  s_cmp_ge_u32 s42, 3192
  s_cbranch_scc1 L_ok164
  s_sleep 2
  s_branch L_cw163
  s_nop 9
L_ok164:
  buffer_load_dwordx4 v[184:187], v3, s[68:71], s98 offen nt
  s_add_u32 s98, s98, 5120
  buffer_load_dwordx4 v[188:191], v3, s[68:71], s98 offen nt
  s_add_u32 s98, s98, 5120
  s_nop 9
L_cw165:
  s_memrealtime s[42:43]
  s_waitcnt lgkmcnt(0)
  s_sub_u32 s42, s42, s9
  s_cmp_ge_u32 s42, 3248
  s_cbranch_scc1 L_ok166
  s_sleep 2
  s_branch L_cw165
  s_nop 9
L_ok166:
  buffer_load_dwordx4 v[192:195], v3, s[68:71], s98 offen nt
  s_add_u32 s98, s98, 5120
  buffer_load_dwordx4 v[196:199], v3, s[68:71], s98 offen nt
  s_add_u32 s98, s98, 5120
  s_nop 9
L_cw167:
  s_memrealtime s[42:43]
  s_waitcnt lgkmcnt(0)
  s_sub_u32 s42, s42, s9
  s_cmp_ge_u32 s42, 3304
  s_cbranch_scc1 L_ok168
  s_sleep 2
  s_branch L_cw167
  s_nop 9
L_ok168:
  buffer_load_dwordx4 v[200:203], v3, s[68:71], s98 offen nt
  s_add_u32 s98, s98, 5120
  buffer_load_dwordx4 v[204:207], v3, s[68:71], s98 offen nt
  s_add_u32 s98, s98, 5120
  s_nop 9
L_cw169:
  s_memrealtime s[42:43]
  s_waitcnt lgkmcnt(0)
  s_sub_u32 s42, s42, s9
  s_cmp_ge_u32 s42, 3360
  s_cbranch_scc1 L_ok170
  s_sleep 2
  s_branch L_cw169
  s_nop 9
L_ok170:
  buffer_load_dwordx4 v[208:211], v3, s[68:71], s98 offen nt
  s_add_u32 s98, s98, 5120
  buffer_load_dwordx4 v[212:215], v3, s[68:71], s98 offen nt
  s_add_u32 s98, s98, 5120
  s_nop 9
L_cw171:
  s_memrealtime s[42:43]
  s_waitcnt lgkmcnt(0)
  s_sub_u32 s42, s42, s9
  s_cmp_ge_u32 s42, 3416
  s_cbranch_scc1 L_ok172
  s_sleep 2
  s_branch L_cw171
  s_nop 9
L_ok172:
  buffer_load_dwordx4 v[216:219], v3, s[68:71], s98 offen nt
  s_add_u32 s98, s98, 5120
  buffer_load_dwordx4 v[220:223], v3, s[68:71], s98 offen nt
  s_add_u32 s98, s98, 5120
  s_nop 9
L_cw173:
  s_memrealtime s[42:43]
  s_waitcnt lgkmcnt(0)
  s_sub_u32 s42, s42, s9
  s_cmp_ge_u32 s42, 3472
  s_cbranch_scc1 L_ok174
  s_sleep 2
  s_branch L_cw173
  s_nop 9
L_ok174:
  buffer_load_dwordx4 v[224:227], v3, s[68:71], s98 offen nt
  s_add_u32 s98, s98, 5120
  buffer_load_dwordx4 v[228:231], v3, s[68:71], s98 offen nt
  s_add_u32 s98, s98, 5120
  s_nop 9
L_cw175:
  s_memrealtime s[42:43]
  s_waitcnt lgkmcnt(0)
  s_sub_u32 s42, s42, s9
  s_cmp_ge_u32 s42, 3528
  s_cbranch_scc1 L_ok176
  s_sleep 2
  s_branch L_cw175
  s_nop 9
L_ok176:
  buffer_load_dwordx4 v[232:235], v3, s[68:71], s98 offen nt
  s_add_u32 s98, s98, 5120
  buffer_load_dwordx4 v[236:239], v3, s[68:71], s98 offen nt
  s_add_u32 s98, s98, 5120
  s_nop 9
L_cw177:
  s_memrealtime s[42:43]
  s_waitcnt lgkmcnt(0)
  s_sub_u32 s42, s42, s9
  s_cmp_ge_u32 s42, 3584
  s_cbranch_scc1 L_ok178
  s_sleep 2
  s_branch L_cw177
  s_nop 9
L_ok178:
  buffer_load_dwordx4 v[240:243], v3, s[68:71], s98 offen nt
  s_add_u32 s98, s98, 5120
  buffer_load_dwordx4 v[244:247], v3, s[68:71], s98 offen nt
  s_add_u32 s98, s98, 5120
  s_nop 9
L_cw179:
  s_memrealtime s[42:43]
  s_waitcnt lgkmcnt(0)
  s_sub_u32 s42, s42, s9
  s_cmp_ge_u32 s42, 3640
  s_cbranch_scc1 L_ok180
  s_sleep 2
  s_branch L_cw179
  s_nop 9
L_ok180:
  buffer_load_dwordx4 v[248:251], v3, s[68:71], s98 offen nt
  s_add_u32 s98, s98, 5120
  buffer_load_dwordx4 v[252:255], v3, s[68:71], s98 offen nt
L_hop4930:
  s_cbranch_execz L_hop4936
  s_cmp_eq_u32 s53, 0
  s_cbranch_scc1 L_cons
  v_lshlrev_b32 v9, 5, v43
  v_lshl_add_u32 v9, v42, 4, v9
  v_lshl_add_u32 v8, v43, 2, v42
L_hop4936:
  s_cbranch_execz L_hop4962
  v_lshlrev_b32 v8, 2, v8
  v_mov_b32 v10, 0xffffff00
  v_lshrrev_b32 v8, 1, v43
  v_lshl_add_u32 v8, v8, 2, v42
  v_lshlrev_b32 v8, 2, v8
  v_add_u32 v8, 2048, v8
  v_add_u32 v80, 1024, v8
  v_and_b32 v82, 1, v43
  v_lshlrev_b32 v82, 4, v82
  v_mov_b32 v81, 0xffff
  v_lshlrev_b32 v81, v82, v81
  v_mov_b32 v12, 0
  v_mov_b32 v13, 0
  v_mov_b32 v14, 0
  v_mov_b32 v15, 0
  v_mov_b32 v16, 0
  v_mov_b32 v17, 0
  v_mov_b32 v18, 0
  v_mov_b32 v19, 0
  v_lshrrev_b32 v82, 1, v42
  v_lshlrev_b32 v9, 5, v43
  v_lshl_add_u32 v9, v82, 4, v9
  s_waitcnt vmcnt(0)
  s_cmp_lg_u32 s54, 0
  s_cbranch_scc1 L_nz181
L_hop4962:
  s_cbranch_execz L_hop4986
  s_nop 9
L_cw182:
  s_memrealtime s[42:43]
  s_waitcnt lgkmcnt(0)
  s_sub_u32 s42, s42, s9
  s_cmp_ge_u32 s42, 3983
  s_cbranch_scc1 L_ok183
  s_sleep 2
  s_branch L_cw182
  s_nop 9
L_ok183:
  buffer_store_dwordx4 v[120:123], v1, s[64:67], s48 offen sc1
  buffer_store_dwordx4 v[124:127], v1, s[64:67], s48 offen offset:1024 sc1
  s_nop 9
L_nz181:
  s_barrier
  ds_read2_b32 v[64:65], v8 offset0:0 offset1:32
  ds_read2_b32 v[68:69], v8 offset0:128 offset1:160
  ds_read2_b32 v[72:73], v80 offset0:0 offset1:32
  ds_read2_b32 v[76:77], v80 offset0:128 offset1:160
  ds_read2_b32 v[66:67], v8 offset0:64 offset1:96
  ds_read2_b32 v[70:71], v8 offset0:192 offset1:224
  ds_read2_b32 v[74:75], v80 offset0:64 offset1:96
L_hop4986:
  s_cbranch_execz L_hop5007
  ds_read2_b32 v[78:79], v80 offset0:192 offset1:224
  s_waitcnt lgkmcnt(4)
  v_add_f32 v64, v64, v68
  v_add_f32 v72, v72, v76
  v_add_f32 v64, v64, v72
  v_cvt_pk_bf16_f32 v96, v64, v64
  v_add_f32 v65, v65, v69
  v_add_f32 v73, v73, v77
  v_add_f32 v65, v65, v73
  v_cvt_pk_bf16_f32 v97, v65, v65
  v_and_b32_dpp v12, v96, v81 quad_perm:[0,1,2,3] row_mask:0xf bank_mask:0x1
  v_and_b32_dpp v13, v96, v81 row_ror:4 row_mask:0xf bank_mask:0x2
  v_and_b32_dpp v14, v96, v81 row_ror:8 row_mask:0xf bank_mask:0x4
  v_and_b32_dpp v15, v96, v81 row_ror:12 row_mask:0xf bank_mask:0x8
  s_nop 1
  v_mfma_f32_16x16x32_bf16 v[100:103], v[12:15], v[128:131], 0
  v_and_b32_dpp v16, v96, v81 row_ror:12 row_mask:0xf bank_mask:0x1
  v_and_b32_dpp v17, v96, v81 quad_perm:[0,1,2,3] row_mask:0xf bank_mask:0x2
  v_and_b32_dpp v18, v96, v81 row_ror:4 row_mask:0xf bank_mask:0x4
  v_and_b32_dpp v19, v96, v81 row_ror:8 row_mask:0xf bank_mask:0x8
L_hop5007:
  s_cbranch_execz L_hop5026
  v_mfma_f32_16x16x32_bf16 v[104:107], v[12:15], v[132:135], 0
  s_nop 0
  v_mfma_f32_16x16x32_bf16 v[100:103], v[16:19], v[136:139], v[100:103]
  v_and_b32_dpp v12, v96, v81 row_ror:8 row_mask:0xf bank_mask:0x1
  v_and_b32_dpp v13, v96, v81 row_ror:12 row_mask:0xf bank_mask:0x2
  v_and_b32_dpp v14, v96, v81 quad_perm:[0,1,2,3] row_mask:0xf bank_mask:0x4
  v_and_b32_dpp v15, v96, v81 row_ror:4 row_mask:0xf bank_mask:0x8
  v_mfma_f32_16x16x32_bf16 v[104:107], v[16:19], v[140:143], v[104:107]
  s_waitcnt lgkmcnt(0)
  v_add_f32 v66, v66, v70
  v_add_f32 v74, v74, v78
  v_add_f32 v66, v66, v74
  v_cvt_pk_bf16_f32 v98, v66, v66
  v_mfma_f32_16x16x32_bf16 v[100:103], v[12:15], v[144:147], v[100:103]
  v_and_b32_dpp v16, v96, v81 row_ror:4 row_mask:0xf bank_mask:0x1
  v_and_b32_dpp v17, v96, v81 row_ror:8 row_mask:0xf bank_mask:0x2
  v_and_b32_dpp v18, v96, v81 row_ror:12 row_mask:0xf bank_mask:0x4
  v_and_b32_dpp v19, v96, v81 quad_perm:[0,1,2,3] row_mask:0xf bank_mask:0x8
L_hop5026:
  s_cbranch_execz L_hop5044
  v_mfma_f32_16x16x32_bf16 v[104:107], v[12:15], v[148:151], v[104:107]
  v_add_f32 v67, v67, v71
  v_add_f32 v75, v75, v79
  v_add_f32 v67, v67, v75
  v_cvt_pk_bf16_f32 v99, v67, v67
  v_mfma_f32_16x16x32_bf16 v[100:103], v[16:19], v[152:155], v[100:103]
  v_and_b32_dpp v12, v97, v81 quad_perm:[0,1,2,3] row_mask:0xf bank_mask:0x1
  v_and_b32_dpp v13, v97, v81 row_ror:4 row_mask:0xf bank_mask:0x2
  v_and_b32_dpp v14, v97, v81 row_ror:8 row_mask:0xf bank_mask:0x4
  v_and_b32_dpp v15, v97, v81 row_ror:12 row_mask:0xf bank_mask:0x8
  v_mfma_f32_16x16x32_bf16 v[104:107], v[16:19], v[156:159], v[104:107]
  s_nop 0
  v_mfma_f32_16x16x32_bf16 v[100:103], v[12:15], v[160:163], v[100:103]
  v_and_b32_dpp v16, v97, v81 row_ror:12 row_mask:0xf bank_mask:0x1
  v_and_b32_dpp v17, v97, v81 quad_perm:[0,1,2,3] row_mask:0xf bank_mask:0x2
  v_and_b32_dpp v18, v97, v81 row_ror:4 row_mask:0xf bank_mask:0x4
  v_and_b32_dpp v19, v97, v81 row_ror:8 row_mask:0xf bank_mask:0x8
L_hop5044:
  s_cbranch_execz L_hop5062
  v_mfma_f32_16x16x32_bf16 v[104:107], v[12:15], v[164:167], v[104:107]
  s_nop 0
  v_mfma_f32_16x16x32_bf16 v[100:103], v[16:19], v[168:171], v[100:103]
  v_and_b32_dpp v12, v97, v81 row_ror:8 row_mask:0xf bank_mask:0x1
  v_and_b32_dpp v13, v97, v81 row_ror:12 row_mask:0xf bank_mask:0x2
  v_and_b32_dpp v14, v97, v81 quad_perm:[0,1,2,3] row_mask:0xf bank_mask:0x4
  v_and_b32_dpp v15, v97, v81 row_ror:4 row_mask:0xf bank_mask:0x8
  v_mfma_f32_16x16x32_bf16 v[104:107], v[16:19], v[172:175], v[104:107]
  s_nop 0
  v_mfma_f32_16x16x32_bf16 v[100:103], v[12:15], v[176:179], v[100:103]
  v_and_b32_dpp v16, v97, v81 row_ror:4 row_mask:0xf bank_mask:0x1
  v_and_b32_dpp v17, v97, v81 row_ror:8 row_mask:0xf bank_mask:0x2
  v_and_b32_dpp v18, v97, v81 row_ror:12 row_mask:0xf bank_mask:0x4
  v_and_b32_dpp v19, v97, v81 quad_perm:[0,1,2,3] row_mask:0xf bank_mask:0x8
  v_mfma_f32_16x16x32_bf16 v[104:107], v[12:15], v[180:183], v[104:107]
  s_nop 0
  v_mfma_f32_16x16x32_bf16 v[100:103], v[16:19], v[184:187], v[100:103]
L_hop5062:
  s_cbranch_execz L_hop5080
  v_and_b32_dpp v12, v98, v81 quad_perm:[0,1,2,3] row_mask:0xf bank_mask:0x1
  v_and_b32_dpp v13, v98, v81 row_ror:4 row_mask:0xf bank_mask:0x2
  v_and_b32_dpp v14, v98, v81 row_ror:8 row_mask:0xf bank_mask:0x4
  v_and_b32_dpp v15, v98, v81 row_ror:12 row_mask:0xf bank_mask:0x8
  v_mfma_f32_16x16x32_bf16 v[104:107], v[16:19], v[188:191], v[104:107]
  s_nop 0
  v_mfma_f32_16x16x32_bf16 v[100:103], v[12:15], v[192:195], v[100:103]
  v_and_b32_dpp v16, v98, v81 row_ror:12 row_mask:0xf bank_mask:0x1
  v_and_b32_dpp v17, v98, v81 quad_perm:[0,1,2,3] row_mask:0xf bank_mask:0x2
  v_and_b32_dpp v18, v98, v81 row_ror:4 row_mask:0xf bank_mask:0x4
  v_and_b32_dpp v19, v98, v81 row_ror:8 row_mask:0xf bank_mask:0x8
  v_mfma_f32_16x16x32_bf16 v[104:107], v[12:15], v[196:199], v[104:107]
  s_nop 0
  v_mfma_f32_16x16x32_bf16 v[100:103], v[16:19], v[200:203], v[100:103]
  v_and_b32_dpp v12, v98, v81 row_ror:8 row_mask:0xf bank_mask:0x1
  v_and_b32_dpp v13, v98, v81 row_ror:12 row_mask:0xf bank_mask:0x2
  v_and_b32_dpp v14, v98, v81 quad_perm:[0,1,2,3] row_mask:0xf bank_mask:0x4
L_hop5080:
  s_cbranch_execz L_hop5097
  v_and_b32_dpp v15, v98, v81 row_ror:4 row_mask:0xf bank_mask:0x8
  v_mfma_f32_16x16x32_bf16 v[104:107], v[16:19], v[204:207], v[104:107]
  s_nop 0
  v_mfma_f32_16x16x32_bf16 v[100:103], v[12:15], v[208:211], v[100:103]
  v_and_b32_dpp v16, v98, v81 row_ror:4 row_mask:0xf bank_mask:0x1
  v_and_b32_dpp v17, v98, v81 row_ror:8 row_mask:0xf bank_mask:0x2
  v_and_b32_dpp v18, v98, v81 row_ror:12 row_mask:0xf bank_mask:0x4
  v_and_b32_dpp v19, v98, v81 quad_perm:[0,1,2,3] row_mask:0xf bank_mask:0x8
  v_mfma_f32_16x16x32_bf16 v[104:107], v[12:15], v[212:215], v[104:107]
  s_nop 0
  v_mfma_f32_16x16x32_bf16 v[100:103], v[16:19], v[216:219], v[100:103]
  v_and_b32_dpp v12, v99, v81 quad_perm:[0,1,2,3] row_mask:0xf bank_mask:0x1
  v_and_b32_dpp v13, v99, v81 row_ror:4 row_mask:0xf bank_mask:0x2
  v_and_b32_dpp v14, v99, v81 row_ror:8 row_mask:0xf bank_mask:0x4
  v_and_b32_dpp v15, v99, v81 row_ror:12 row_mask:0xf bank_mask:0x8
  v_mfma_f32_16x16x32_bf16 v[104:107], v[16:19], v[220:223], v[104:107]
L_hop5097:
  s_cbranch_execz L_hop5115
  s_nop 0
  v_mfma_f32_16x16x32_bf16 v[100:103], v[12:15], v[224:227], v[100:103]
  v_and_b32_dpp v16, v99, v81 row_ror:12 row_mask:0xf bank_mask:0x1
  v_and_b32_dpp v17, v99, v81 quad_perm:[0,1,2,3] row_mask:0xf bank_mask:0x2
  v_and_b32_dpp v18, v99, v81 row_ror:4 row_mask:0xf bank_mask:0x4
  v_and_b32_dpp v19, v99, v81 row_ror:8 row_mask:0xf bank_mask:0x8
  v_mfma_f32_16x16x32_bf16 v[104:107], v[12:15], v[228:231], v[104:107]
  s_nop 0
  v_mfma_f32_16x16x32_bf16 v[100:103], v[16:19], v[232:235], v[100:103]
  v_and_b32_dpp v12, v99, v81 row_ror:8 row_mask:0xf bank_mask:0x1
  v_and_b32_dpp v13, v99, v81 row_ror:12 row_mask:0xf bank_mask:0x2
  v_and_b32_dpp v14, v99, v81 quad_perm:[0,1,2,3] row_mask:0xf bank_mask:0x4
  v_and_b32_dpp v15, v99, v81 row_ror:4 row_mask:0xf bank_mask:0x8
  v_mfma_f32_16x16x32_bf16 v[104:107], v[16:19], v[236:239], v[104:107]
  s_nop 0
  v_mfma_f32_16x16x32_bf16 v[100:103], v[12:15], v[240:243], v[100:103]
  v_and_b32_dpp v16, v99, v81 row_ror:4 row_mask:0xf bank_mask:0x1
L_hop5115:
  s_cbranch_execz L_hop5135
  v_and_b32_dpp v17, v99, v81 row_ror:8 row_mask:0xf bank_mask:0x2
  v_and_b32_dpp v18, v99, v81 row_ror:12 row_mask:0xf bank_mask:0x4
  v_and_b32_dpp v19, v99, v81 quad_perm:[0,1,2,3] row_mask:0xf bank_mask:0x8
  v_mfma_f32_16x16x32_bf16 v[104:107], v[12:15], v[244:247], v[104:107]
  s_nop 0
  v_mfma_f32_16x16x32_bf16 v[100:103], v[16:19], v[248:251], v[100:103]
  v_mfma_f32_16x16x32_bf16 v[104:107], v[16:19], v[252:255], v[104:107]
  s_nop 7
  v_add_f32 v64, v100, v106
  v_add_f32 v65, v101, v107
  v_add_u32 v64, 0x80, v64
  v_add_u32 v65, 0x80, v65
  s_nop 0
  v_permlane16_swap_b32 v64, v66
  v_permlane16_swap_b32 v65, v67
  v_and_or_b32 v64, v64, v10, s56
  v_and_or_b32 v65, v65, v10, s57
  v_and_or_b32 v66, v66, v10, s58
  v_and_or_b32 v67, v67, v10, s59
L_hop5135:
  s_cbranch_execz L_hop5160
  s_mov_b32 exec_lo, 0xffff
  s_mov_b32 exec_hi, 0xffff
  buffer_store_dwordx4 v[64:67], v9, s[64:67], s96 offen sc1
  s_mov_b64 exec, -1
  s_endpgm
  s_nop 9
L_cons:
  v_lshrrev_b32 v45, 2, v40
  v_and_b32 v46, 3, v40
  v_lshlrev_b32 v34, 11, v45
  v_lshl_add_u32 v34, v46, 4, v34
  v_add_u32 v36, 32768, v34
  v_mov_b32 v52, 0
  v_mov_b32 v53, 0
  v_mov_b32 v54, 0
  v_mov_b32 v55, 0
  v_mul_u32_u24 v35, 2560, v45
  v_lshl_add_u32 v35, v46, 4, v35
  v_mul_u32_u24 v41, 5, v45
  v_add_u32 v41, s8, v41
  v_and_b32 v41, 7, v41
  v_lshlrev_b32 v41, 2, v41
  ds_bpermute_b32 v112, v41, v37
  v_lshrrev_b32 v44, 5, v40
L_hop5160:
  s_cbranch_execz L_hop5181
  v_lshlrev_b32 v44, 2, v44
  ds_bpermute_b32 v116, v44, v37 offset:0
  ds_bpermute_b32 v117, v44, v37 offset:8
  ds_bpermute_b32 v118, v44, v37 offset:16
  ds_bpermute_b32 v119, v44, v37 offset:24
  s_waitcnt lgkmcnt(0)
  s_add_u32 s68, s51, 0
  s_add_u32 s69, s51, 40960
  s_add_u32 s70, s51, 81920
  s_add_u32 s71, s51, 122880
  v_lshlrev_b32 v32, 3, v40
  v_lshlrev_b32 v9, 5, v43
  v_lshl_add_u32 v9, v42, 4, v9
  v_lshl_add_u32 v8, v43, 2, v42
  v_lshlrev_b32 v8, 2, v8
  v_mov_b32 v10, 0xffffff00
  v_lshrrev_b32 v8, 1, v43
  v_lshl_add_u32 v8, v8, 2, v42
  v_lshlrev_b32 v8, 2, v8
  v_add_u32 v8, 2048, v8
L_hop5181:
  s_cbranch_execz L_hop5210
  v_add_u32 v80, 1024, v8
  v_and_b32 v82, 1, v43
  v_lshlrev_b32 v82, 4, v82
  v_mov_b32 v81, 0xffff
  v_lshlrev_b32 v81, v82, v81
  v_mov_b32 v12, 0
  v_mov_b32 v13, 0
  v_mov_b32 v14, 0
  v_mov_b32 v15, 0
  v_mov_b32 v16, 0
  v_mov_b32 v17, 0
  v_mov_b32 v18, 0
  v_mov_b32 v19, 0
  v_lshrrev_b32 v82, 1, v42
  v_lshlrev_b32 v9, 5, v43
  v_lshl_add_u32 v9, v82, 4, v9
  s_waitcnt vmcnt(0)
  s_cmp_lg_u32 s54, 0
  s_cbranch_scc1 L_nz184
  s_nop 9
L_cw185:
  s_memrealtime s[42:43]
  s_waitcnt lgkmcnt(0)
  s_sub_u32 s42, s42, s9
  s_cmp_ge_u32 s42, 3983
  s_cbranch_scc1 L_ok186
  s_sleep 2
  s_branch L_cw185
L_hop5210:
  s_cbranch_execz L_hop5231
  s_nop 9
L_ok186:
  buffer_store_dwordx4 v[120:123], v1, s[64:67], s48 offen sc1
  buffer_store_dwordx4 v[124:127], v1, s[64:67], s48 offen offset:1024 sc1
  s_nop 9
L_nz184:
  s_barrier
  ds_read2_b32 v[64:65], v8 offset0:0 offset1:32
  ds_read2_b32 v[68:69], v8 offset0:128 offset1:160
  ds_read2_b32 v[72:73], v80 offset0:0 offset1:32
  ds_read2_b32 v[76:77], v80 offset0:128 offset1:160
  ds_read2_b32 v[66:67], v8 offset0:64 offset1:96
  ds_read2_b32 v[70:71], v8 offset0:192 offset1:224
  ds_read2_b32 v[74:75], v80 offset0:64 offset1:96
  ds_read2_b32 v[78:79], v80 offset0:192 offset1:224
  s_waitcnt lgkmcnt(4)
  v_add_f32 v64, v64, v68
  v_add_f32 v72, v72, v76
  v_add_f32 v64, v64, v72
  v_cvt_pk_bf16_f32 v96, v64, v64
L_hop5231:
  s_cbranch_execz L_hop5250
  v_add_f32 v65, v65, v69
  v_add_f32 v73, v73, v77
  v_add_f32 v65, v65, v73
  v_cvt_pk_bf16_f32 v97, v65, v65
  v_and_b32_dpp v12, v96, v81 quad_perm:[0,1,2,3] row_mask:0xf bank_mask:0x1
  v_and_b32_dpp v13, v96, v81 row_ror:4 row_mask:0xf bank_mask:0x2
  v_and_b32_dpp v14, v96, v81 row_ror:8 row_mask:0xf bank_mask:0x4
  v_and_b32_dpp v15, v96, v81 row_ror:12 row_mask:0xf bank_mask:0x8
  s_nop 1
  v_mfma_f32_16x16x32_bf16 v[100:103], v[12:15], v[128:131], 0
  v_and_b32_dpp v16, v96, v81 row_ror:12 row_mask:0xf bank_mask:0x1
  v_and_b32_dpp v17, v96, v81 quad_perm:[0,1,2,3] row_mask:0xf bank_mask:0x2
  v_and_b32_dpp v18, v96, v81 row_ror:4 row_mask:0xf bank_mask:0x4
  v_and_b32_dpp v19, v96, v81 row_ror:8 row_mask:0xf bank_mask:0x8
  v_mfma_f32_16x16x32_bf16 v[104:107], v[12:15], v[132:135], 0
  s_nop 0
  v_mfma_f32_16x16x32_bf16 v[100:103], v[16:19], v[136:139], v[100:103]
  v_and_b32_dpp v12, v96, v81 row_ror:8 row_mask:0xf bank_mask:0x1
L_hop5250:
  s_cbranch_execz L_hop5270
  v_and_b32_dpp v13, v96, v81 row_ror:12 row_mask:0xf bank_mask:0x2
  v_and_b32_dpp v14, v96, v81 quad_perm:[0,1,2,3] row_mask:0xf bank_mask:0x4
  v_and_b32_dpp v15, v96, v81 row_ror:4 row_mask:0xf bank_mask:0x8
  v_mfma_f32_16x16x32_bf16 v[104:107], v[16:19], v[140:143], v[104:107]
  s_waitcnt lgkmcnt(0)
  v_add_f32 v66, v66, v70
  v_add_f32 v74, v74, v78
  v_add_f32 v66, v66, v74
  v_cvt_pk_bf16_f32 v98, v66, v66
  v_mfma_f32_16x16x32_bf16 v[100:103], v[12:15], v[144:147], v[100:103]
  v_and_b32_dpp v16, v96, v81 row_ror:4 row_mask:0xf bank_mask:0x1
  v_and_b32_dpp v17, v96, v81 row_ror:8 row_mask:0xf bank_mask:0x2
  v_and_b32_dpp v18, v96, v81 row_ror:12 row_mask:0xf bank_mask:0x4
  v_and_b32_dpp v19, v96, v81 quad_perm:[0,1,2,3] row_mask:0xf bank_mask:0x8
  v_mfma_f32_16x16x32_bf16 v[104:107], v[12:15], v[148:151], v[104:107]
  v_add_f32 v67, v67, v71
  v_add_f32 v75, v75, v79
  v_add_f32 v67, v67, v75
  v_cvt_pk_bf16_f32 v99, v67, v67
L_hop5270:
  s_cbranch_execz L_hop5288
  v_mfma_f32_16x16x32_bf16 v[100:103], v[16:19], v[152:155], v[100:103]
  v_and_b32_dpp v12, v97, v81 quad_perm:[0,1,2,3] row_mask:0xf bank_mask:0x1
  v_and_b32_dpp v13, v97, v81 row_ror:4 row_mask:0xf bank_mask:0x2
  v_and_b32_dpp v14, v97, v81 row_ror:8 row_mask:0xf bank_mask:0x4
  v_and_b32_dpp v15, v97, v81 row_ror:12 row_mask:0xf bank_mask:0x8
  v_mfma_f32_16x16x32_bf16 v[104:107], v[16:19], v[156:159], v[104:107]
  s_nop 0
  v_mfma_f32_16x16x32_bf16 v[100:103], v[12:15], v[160:163], v[100:103]
  v_and_b32_dpp v16, v97, v81 row_ror:12 row_mask:0xf bank_mask:0x1
  v_and_b32_dpp v17, v97, v81 quad_perm:[0,1,2,3] row_mask:0xf bank_mask:0x2
  v_and_b32_dpp v18, v97, v81 row_ror:4 row_mask:0xf bank_mask:0x4
  v_and_b32_dpp v19, v97, v81 row_ror:8 row_mask:0xf bank_mask:0x8
  v_mfma_f32_16x16x32_bf16 v[104:107], v[12:15], v[164:167], v[104:107]
  s_nop 0
  v_mfma_f32_16x16x32_bf16 v[100:103], v[16:19], v[168:171], v[100:103]
  v_and_b32_dpp v12, v97, v81 row_ror:8 row_mask:0xf bank_mask:0x1
  v_and_b32_dpp v13, v97, v81 row_ror:12 row_mask:0xf bank_mask:0x2
L_hop5288:
  s_cbranch_execz L_hop5305
  v_and_b32_dpp v14, v97, v81 quad_perm:[0,1,2,3] row_mask:0xf bank_mask:0x4
  v_and_b32_dpp v15, v97, v81 row_ror:4 row_mask:0xf bank_mask:0x8
  v_mfma_f32_16x16x32_bf16 v[104:107], v[16:19], v[172:175], v[104:107]
  s_nop 0
  v_mfma_f32_16x16x32_bf16 v[100:103], v[12:15], v[176:179], v[100:103]
  v_and_b32_dpp v16, v97, v81 row_ror:4 row_mask:0xf bank_mask:0x1
  v_and_b32_dpp v17, v97, v81 row_ror:8 row_mask:0xf bank_mask:0x2
  v_and_b32_dpp v18, v97, v81 row_ror:12 row_mask:0xf bank_mask:0x4
  v_and_b32_dpp v19, v97, v81 quad_perm:[0,1,2,3] row_mask:0xf bank_mask:0x8
  v_mfma_f32_16x16x32_bf16 v[104:107], v[12:15], v[180:183], v[104:107]
  s_nop 0
  v_mfma_f32_16x16x32_bf16 v[100:103], v[16:19], v[184:187], v[100:103]
  v_and_b32_dpp v12, v98, v81 quad_perm:[0,1,2,3] row_mask:0xf bank_mask:0x1
  v_and_b32_dpp v13, v98, v81 row_ror:4 row_mask:0xf bank_mask:0x2
  v_and_b32_dpp v14, v98, v81 row_ror:8 row_mask:0xf bank_mask:0x4
  v_and_b32_dpp v15, v98, v81 row_ror:12 row_mask:0xf bank_mask:0x8
L_hop5305:
  s_cbranch_execz L_hop5323
  v_mfma_f32_16x16x32_bf16 v[104:107], v[16:19], v[188:191], v[104:107]
  s_nop 0
  v_mfma_f32_16x16x32_bf16 v[100:103], v[12:15], v[192:195], v[100:103]
  v_and_b32_dpp v16, v98, v81 row_ror:12 row_mask:0xf bank_mask:0x1
  v_and_b32_dpp v17, v98, v81 quad_perm:[0,1,2,3] row_mask:0xf bank_mask:0x2
  v_and_b32_dpp v18, v98, v81 row_ror:4 row_mask:0xf bank_mask:0x4
  v_and_b32_dpp v19, v98, v81 row_ror:8 row_mask:0xf bank_mask:0x8
  v_mfma_f32_16x16x32_bf16 v[104:107], v[12:15], v[196:199], v[104:107]
  s_nop 0
  v_mfma_f32_16x16x32_bf16 v[100:103], v[16:19], v[200:203], v[100:103]
  v_and_b32_dpp v12, v98, v81 row_ror:8 row_mask:0xf bank_mask:0x1
  v_and_b32_dpp v13, v98, v81 row_ror:12 row_mask:0xf bank_mask:0x2
  v_and_b32_dpp v14, v98, v81 quad_perm:[0,1,2,3] row_mask:0xf bank_mask:0x4
  v_and_b32_dpp v15, v98, v81 row_ror:4 row_mask:0xf bank_mask:0x8
  v_mfma_f32_16x16x32_bf16 v[104:107], v[16:19], v[204:207], v[104:107]
  s_nop 0
  v_mfma_f32_16x16x32_bf16 v[100:103], v[12:15], v[208:211], v[100:103]
L_hop5323:
  s_cbranch_execz L_hop5341
  v_and_b32_dpp v16, v98, v81 row_ror:4 row_mask:0xf bank_mask:0x1
  v_and_b32_dpp v17, v98, v81 row_ror:8 row_mask:0xf bank_mask:0x2
  v_and_b32_dpp v18, v98, v81 row_ror:12 row_mask:0xf bank_mask:0x4
  v_and_b32_dpp v19, v98, v81 quad_perm:[0,1,2,3] row_mask:0xf bank_mask:0x8
  v_mfma_f32_16x16x32_bf16 v[104:107], v[12:15], v[212:215], v[104:107]
  s_nop 0
  v_mfma_f32_16x16x32_bf16 v[100:103], v[16:19], v[216:219], v[100:103]
  v_and_b32_dpp v12, v99, v81 quad_perm:[0,1,2,3] row_mask:0xf bank_mask:0x1
  v_and_b32_dpp v13, v99, v81 row_ror:4 row_mask:0xf bank_mask:0x2
  v_and_b32_dpp v14, v99, v81 row_ror:8 row_mask:0xf bank_mask:0x4
  v_and_b32_dpp v15, v99, v81 row_ror:12 row_mask:0xf bank_mask:0x8
  v_mfma_f32_16x16x32_bf16 v[104:107], v[16:19], v[220:223], v[104:107]
  s_nop 0
  v_mfma_f32_16x16x32_bf16 v[100:103], v[12:15], v[224:227], v[100:103]
  v_and_b32_dpp v16, v99, v81 row_ror:12 row_mask:0xf bank_mask:0x1
  v_and_b32_dpp v17, v99, v81 quad_perm:[0,1,2,3] row_mask:0xf bank_mask:0x2
  v_and_b32_dpp v18, v99, v81 row_ror:4 row_mask:0xf bank_mask:0x4
L_hop5341:
  s_cbranch_execz L_hop5358
  v_and_b32_dpp v19, v99, v81 row_ror:8 row_mask:0xf bank_mask:0x8
  v_mfma_f32_16x16x32_bf16 v[104:107], v[12:15], v[228:231], v[104:107]
  s_nop 0
  v_mfma_f32_16x16x32_bf16 v[100:103], v[16:19], v[232:235], v[100:103]
  v_and_b32_dpp v12, v99, v81 row_ror:8 row_mask:0xf bank_mask:0x1
  v_and_b32_dpp v13, v99, v81 row_ror:12 row_mask:0xf bank_mask:0x2
  v_and_b32_dpp v14, v99, v81 quad_perm:[0,1,2,3] row_mask:0xf bank_mask:0x4
  v_and_b32_dpp v15, v99, v81 row_ror:4 row_mask:0xf bank_mask:0x8
  v_mfma_f32_16x16x32_bf16 v[104:107], v[16:19], v[236:239], v[104:107]
  s_nop 0
  v_mfma_f32_16x16x32_bf16 v[100:103], v[12:15], v[240:243], v[100:103]
  v_and_b32_dpp v16, v99, v81 row_ror:4 row_mask:0xf bank_mask:0x1
  v_and_b32_dpp v17, v99, v81 row_ror:8 row_mask:0xf bank_mask:0x2
  v_and_b32_dpp v18, v99, v81 row_ror:12 row_mask:0xf bank_mask:0x4
  v_and_b32_dpp v19, v99, v81 quad_perm:[0,1,2,3] row_mask:0xf bank_mask:0x8
  v_mfma_f32_16x16x32_bf16 v[104:107], v[12:15], v[244:247], v[104:107]
L_hop5358:
  s_cbranch_execz L_hop5379
  s_nop 0
  v_mfma_f32_16x16x32_bf16 v[100:103], v[16:19], v[248:251], v[100:103]
  v_mfma_f32_16x16x32_bf16 v[104:107], v[16:19], v[252:255], v[104:107]
  s_nop 7
  v_add_f32 v64, v100, v106
  v_add_f32 v65, v101, v107
  v_add_u32 v64, 0x80, v64
  v_add_u32 v65, 0x80, v65
  s_nop 0
  v_permlane16_swap_b32 v64, v66
  v_permlane16_swap_b32 v65, v67
  v_and_or_b32 v64, v64, v10, s56
  v_and_or_b32 v65, v65, v10, s57
  v_and_or_b32 v66, v66, v10, s58
  v_and_or_b32 v67, v67, v10, s59
  s_mov_b32 exec_lo, 0xffff
  s_mov_b32 exec_hi, 0xffff
  buffer_store_dwordx4 v[64:67], v9, s[64:67], s96 offen sc1
  s_mov_b64 exec, -1
  s_mov_b32 s76, -1
L_hop5379:
  s_cbranch_execz L_hop5411
  s_mov_b32 s77, 0xfff
  s_mov_b64 s[24:25], -1
  s_mov_b64 s[26:27], s[76:77]
  s_mov_b32 s97, 0
  s_nop 9
L_sp188:
  s_mov_b64 exec, s[24:25]
  buffer_load_dwordx4 v[48:51], v34, s[64:67], s49 offen sc1
  s_mov_b64 exec, s[26:27]
  buffer_load_dwordx4 v[52:55], v36, s[64:67], s49 offen sc1
  s_mov_b64 exec, -1
  s_add_u32 s97, s97, 1
  s_waitcnt vmcnt(1)
  v_perm_b32 v56, v49, v48, s4
  v_perm_b32 v57, v51, v50, s5
  s_waitcnt vmcnt(0)
  v_perm_b32 v58, v53, v52, s4
  v_perm_b32 v59, v55, v54, s5
  v_or_b32 v56, v56, v57
  v_or_b32 v58, v58, v59
  s_mov_b64 exec, s[24:25]
  v_cmp_ne_u32 s[24:25], v112, v56
  s_mov_b64 exec, s[26:27]
  v_cmp_ne_u32 s[26:27], v112, v58
  s_mov_b64 exec, -1
  s_or_b64 s[74:75], s[24:25], s[26:27]
  s_cbranch_scc0 L_ok187
  s_cmp_gt_u32 s97, 20000
  s_cbranch_scc1 L_ok187
  s_sleep 16
  s_branch L_sp188
L_hop5411:
  s_cbranch_execz L_hop5431
  s_nop 9
L_ok187:
  v_and_b32 v48, s6, v48
  v_and_b32 v49, s6, v49
  v_and_b32 v50, s6, v50
  v_and_b32 v51, s6, v51
  v_and_b32 v52, s6, v52
  v_and_b32 v53, s6, v53
  v_and_b32 v54, s6, v54
  v_and_b32 v55, s6, v55
  v_add_f32 v24, v48, v52
  v_add_f32 v25, v49, v53
  v_add_f32 v26, v50, v54
  v_add_f32 v27, v51, v55
  v_add_f32_dpp v24, v24, v24 row_ror:4 row_mask:0xf bank_mask:0xf
  v_add_f32_dpp v25, v25, v25 row_ror:4 row_mask:0xf bank_mask:0xf
  v_add_f32_dpp v26, v26, v26 row_ror:4 row_mask:0xf bank_mask:0xf
  v_add_f32_dpp v27, v27, v27 row_ror:4 row_mask:0xf bank_mask:0xf
  v_add_f32_dpp v24, v24, v24 row_ror:8 row_mask:0xf bank_mask:0xf
L_hop5431:
  s_cbranch_execz L_hop5459
  v_add_f32_dpp v25, v25, v25 row_ror:8 row_mask:0xf bank_mask:0xf
  v_add_f32_dpp v26, v26, v26 row_ror:8 row_mask:0xf bank_mask:0xf
  v_add_f32_dpp v27, v27, v27 row_ror:8 row_mask:0xf bank_mask:0xf
  v_mov_b32 v48, v24
  v_mov_b32 v49, v25
  v_mov_b32 v50, v26
  v_mov_b32 v51, v27
  v_permlane16_swap_b32 v24, v48
  v_permlane16_swap_b32 v25, v49
  v_permlane16_swap_b32 v26, v50
  v_permlane16_swap_b32 v27, v51
  v_add_f32 v24, v24, v48
  v_add_f32 v25, v25, v49
  v_add_f32 v26, v26, v50
  v_add_f32 v27, v27, v51
  v_mov_b32 v48, v24
  v_mov_b32 v49, v25
  v_mov_b32 v50, v26
  v_mov_b32 v51, v27
  v_permlane32_swap_b32 v24, v48
  v_permlane32_swap_b32 v25, v49
  v_permlane32_swap_b32 v26, v50
  v_permlane32_swap_b32 v27, v51
  v_add_f32 v24, v24, v48
  v_add_f32 v25, v25, v49
  v_add_f32 v26, v26, v50
  v_add_f32 v27, v27, v51
L_hop5459:
  s_cbranch_execz L_hop5489
  v_cvt_pk_bf16_f32 v24, v24, v24
  v_and_b32 v24, s80, v24
  v_cvt_pk_bf16_f32 v25, v25, v25
  v_and_b32 v25, s80, v25
  v_cvt_pk_bf16_f32 v26, v26, v26
  v_and_b32 v26, s80, v26
  v_cvt_pk_bf16_f32 v27, v27, v27
  v_and_b32 v27, s80, v27
  v_mul_f32 v24, v21, v24
  v_mul_f32 v25, v21, v25
  v_mul_f32 v26, v21, v26
  v_mul_f32 v27, v21, v27
  v_cvt_pk_bf16_f32 v24, v24, v24
  v_and_b32 v24, s80, v24
  v_cvt_pk_bf16_f32 v25, v25, v25
  v_and_b32 v25, s80, v25
  v_cvt_pk_bf16_f32 v26, v26, v26
  v_and_b32 v26, s80, v26
  v_cvt_pk_bf16_f32 v27, v27, v27
  v_and_b32 v27, s80, v27
  s_nop 9
L_cw190:
  s_memrealtime s[42:43]
  s_waitcnt lgkmcnt(0)
  s_sub_u32 s42, s42, s9
  s_cmp_ge_u32 s42, 4105
  s_cbranch_scc1 L_ok191
  s_sleep 2
  s_branch L_cw190
L_hop5489:
  s_cbranch_execz L_hop5551
  s_nop 9
L_ok191:
  s_mov_b64 s[24:25], -1
  s_mov_b64 s[26:27], -1
  s_mov_b64 s[28:29], -1
  s_mov_b64 s[30:31], -1
  s_mov_b32 s97, 0
  s_mov_b64 exec, s[24:25]
  buffer_load_dwordx4 v[64:67], v35, s[64:67], s68 offen sc1
  s_mov_b64 exec, s[26:27]
  buffer_load_dwordx4 v[68:71], v35, s[64:67], s69 offen sc1
  s_mov_b64 exec, s[28:29]
  buffer_load_dwordx4 v[72:75], v35, s[64:67], s70 offen sc1
  s_mov_b64 exec, s[30:31]
  buffer_load_dwordx4 v[76:79], v35, s[64:67], s71 offen sc1
  s_mov_b64 exec, -1
  s_sleep 8
  s_nop 9
L_sp193:
  s_mov_b64 exec, s[24:25]
  buffer_load_dwordx4 v[64:67], v35, s[64:67], s68 offen sc1
  s_mov_b64 exec, s[26:27]
  buffer_load_dwordx4 v[68:71], v35, s[64:67], s69 offen sc1
  s_mov_b64 exec, s[28:29]
  buffer_load_dwordx4 v[72:75], v35, s[64:67], s70 offen sc1
  s_mov_b64 exec, s[30:31]
  buffer_load_dwordx4 v[76:79], v35, s[64:67], s71 offen sc1
  s_mov_b64 exec, -1
  s_add_u32 s97, s97, 1
  s_waitcnt vmcnt(7)
  v_perm_b32 v80, v65, v64, s4
  v_perm_b32 v81, v67, v66, s5
  s_waitcnt vmcnt(6)
  v_perm_b32 v82, v69, v68, s4
  v_perm_b32 v83, v71, v70, s5
  s_waitcnt vmcnt(5)
  v_perm_b32 v84, v73, v72, s4
  v_perm_b32 v85, v75, v74, s5
  s_waitcnt vmcnt(4)
  v_perm_b32 v86, v77, v76, s4
  v_perm_b32 v87, v79, v78, s5
  v_or_b32 v80, v80, v81
  v_or_b32 v82, v82, v83
  v_or_b32 v84, v84, v85
  v_or_b32 v86, v86, v87
  s_mov_b64 exec, s[24:25]
  v_cmp_ne_u32 s[24:25], v116, v80
  s_mov_b64 exec, s[26:27]
  v_cmp_ne_u32 s[26:27], v117, v82
  s_mov_b64 exec, s[28:29]
  v_cmp_ne_u32 s[28:29], v118, v84
  s_mov_b64 exec, s[30:31]
  v_cmp_ne_u32 s[30:31], v119, v86
  s_mov_b64 exec, -1
  s_or_b64 s[74:75], s[24:25], s[26:27]
  s_or_b64 s[74:75], s[74:75], s[28:29]
  s_or_b64 s[74:75], s[74:75], s[30:31]
  s_cbranch_scc0 L_ok192
  s_cmp_gt_u32 s97, 20000
  s_cbranch_scc1 L_ok192
  s_branch L_sp193
L_hop5551:
  s_cbranch_execz L_hop5560
  s_nop 9
L_ok192:
  v_and_b32 v48, s6, v64
  v_and_b32 v49, s6, v65
  v_and_b32 v50, s6, v66
  v_and_b32 v51, s6, v67
  v_and_b32 v52, s6, v68
  v_and_b32 v53, s6, v69
L_hop5560:
  s_cbranch_execz L_hop5588
  v_and_b32 v54, s6, v70
  v_and_b32 v55, s6, v71
  v_and_b32 v56, s6, v72
  v_and_b32 v57, s6, v73
  v_and_b32 v58, s6, v74
  v_and_b32 v59, s6, v75
  v_and_b32 v60, s6, v76
  v_and_b32 v61, s6, v77
  v_and_b32 v62, s6, v78
  v_and_b32 v63, s6, v79
  v_add_f32 v48, v48, v52
  v_add_f32 v56, v56, v60
  v_add_f32 v49, v49, v53
  v_add_f32 v57, v57, v61
  v_add_f32 v50, v50, v54
  v_add_f32 v58, v58, v62
  v_add_f32 v51, v51, v55
  v_add_f32 v59, v59, v63
  v_add_f32 v80, v48, v56
  v_add_f32 v81, v49, v57
  v_add_f32 v82, v50, v58
  v_add_f32 v83, v51, v59
  v_add_f32_dpp v80, v80, v80 row_ror:4 row_mask:0xf bank_mask:0xf
  v_add_f32_dpp v81, v81, v81 row_ror:4 row_mask:0xf bank_mask:0xf
  v_add_f32_dpp v82, v82, v82 row_ror:4 row_mask:0xf bank_mask:0xf
  v_add_f32_dpp v83, v83, v83 row_ror:4 row_mask:0xf bank_mask:0xf
  v_add_f32_dpp v80, v80, v80 row_ror:8 row_mask:0xf bank_mask:0xf
L_hop5588:
  s_cbranch_execz L_hop5616
  v_add_f32_dpp v81, v81, v81 row_ror:8 row_mask:0xf bank_mask:0xf
  v_add_f32_dpp v82, v82, v82 row_ror:8 row_mask:0xf bank_mask:0xf
  v_add_f32_dpp v83, v83, v83 row_ror:8 row_mask:0xf bank_mask:0xf
  v_mov_b32 v84, v80
  v_mov_b32 v85, v81
  v_mov_b32 v86, v82
  v_mov_b32 v87, v83
  v_permlane16_swap_b32 v80, v84
  v_permlane16_swap_b32 v81, v85
  v_permlane16_swap_b32 v82, v86
  v_permlane16_swap_b32 v83, v87
  v_add_f32 v80, v80, v84
  v_add_f32 v81, v81, v85
  v_add_f32 v82, v82, v86
  v_add_f32 v83, v83, v87
  v_mov_b32 v84, v80
  v_mov_b32 v85, v81
  v_mov_b32 v86, v82
  v_mov_b32 v87, v83
  v_permlane32_swap_b32 v80, v84
  v_permlane32_swap_b32 v81, v85
  v_permlane32_swap_b32 v82, v86
  v_permlane32_swap_b32 v83, v87
  v_add_f32 v80, v80, v84
  v_add_f32 v81, v81, v85
  v_add_f32 v82, v82, v86
  v_add_f32 v83, v83, v87
L_hop5616:
  s_cbranch_execz L_hop5640
  v_cvt_pk_bf16_f32 v80, v80, v80
  v_and_b32 v80, s80, v80
  v_cvt_pk_bf16_f32 v81, v81, v81
  v_and_b32 v81, s80, v81
  v_cvt_pk_bf16_f32 v82, v82, v82
  v_and_b32 v82, s80, v82
  v_cvt_pk_bf16_f32 v83, v83, v83
  v_and_b32 v83, s80, v83
  v_mul_f32 v80, v20, v80
  v_mul_f32 v81, v20, v81
  v_mul_f32 v82, v20, v82
  v_mul_f32 v83, v20, v83
  v_cvt_pk_bf16_f32 v80, v80, v80
  v_and_b32 v80, s80, v80
  v_cvt_pk_bf16_f32 v81, v81, v81
  v_and_b32 v81, s80, v81
  v_cvt_pk_bf16_f32 v82, v82, v82
  v_and_b32 v82, s80, v82
  v_cvt_pk_bf16_f32 v83, v83, v83
  v_and_b32 v83, s80, v83
  v_add_f32 v80, v80, v24
  v_add_f32 v81, v81, v25
  v_add_f32 v82, v82, v26
L_hop5640:
  s_cbranch_execz L_wret2
  v_add_f32 v83, v83, v27
  v_cvt_pk_bf16_f32 v84, v80, v81
  v_cvt_pk_bf16_f32 v85, v82, v83
  s_mov_b64 exec, 15
  buffer_store_dwordx2 v[84:85], v32, s[20:23], s52 offen
L_end:
  s_endpgm
L_wret0:
  s_cmp_lg_u32 s54, 0
  s_cbranch_scc1 L_wret0a
  s_branch L_wret0b
.section .rodata,"a"
.p2align 6
.amdhsa_kernel gated_mix__mha_block_cached__glu_gated_bilinear__decode_kernel
  .amdhsa_next_free_vgpr 256
  .amdhsa_next_free_sgpr 102
  .amdhsa_accum_offset 256
  .amdhsa_group_segment_fixed_size 0
  .amdhsa_kernarg_size 104
  .amdhsa_user_sgpr_count 2
  .amdhsa_user_sgpr_kernarg_segment_ptr 1
  .amdhsa_system_sgpr_workgroup_id_x 1
  .amdhsa_float_denorm_mode_32 3
.end_amdhsa_kernel
```
